```python
import torch

def _softmax(x, axis=-1):
    return torch.softmax(x, dim=axis)
def _gelu(x):
    return torch.nn.functional.gelu(x, approximate="tanh")
def _silu(x):
    return torch.nn.functional.silu(x)
def _sigmoid(x):
    return torch.sigmoid(x)
def _layernorm(x, axis=-1, eps=1e-5):
    m = x.mean(dim=axis, keepdim=True)
    v = x.var(dim=axis, keepdim=True, unbiased=False)
    return (x - m) / torch.sqrt(v + eps)
def _scatter_add(tgt, idx, src, axis=0):
    return tgt.clone().index_add_(axis, idx, src)
def _segment_sum(src, seg, n):
    out = torch.zeros((n,) + src.shape[1:], dtype=src.dtype)
    return out.index_add_(0, seg, src)
def _pad(x, pw):
    flat = tuple(v for pair in reversed(pw) for v in pair)
    return torch.nn.functional.pad(x, flat)

kernel_name = 'standalone__channel_attn_se__vision'

def setup_inputs():

    _w = (lambda a: (lambda t: t.to(torch.bfloat16) if t.is_floating_point() else t)(torch.as_tensor(a)))
    H = W = 256
    C = 384
    r = max(C // 16, 4)
    return {
        "x": _w((lambda *s: torch.randn(*s, dtype=torch.bfloat16) * 1.6)(1, H, W, C)),
        "w_down": _w((lambda *s: torch.randn(*s, dtype=torch.bfloat16) * 3.2)(C, r)),
        "w_up": _w((lambda *s: torch.randn(*s, dtype=torch.bfloat16) * 1.6)(r, C)),
    }

def reference(x, w_down, w_up):
    s = x.mean(axis=(1, 2))
    h = _silu(torch.einsum('bc,cr->br', s, w_down))
    g = _sigmoid(torch.einsum('br,rc->bc', h, w_up))
    return x * g[:, None, None, :]
```

```asm
; @launch grid=(256,1,1) block=(768,1,1) lds=32768
.amdgcn_target "amdgcn-amd-amdhsa--gfx950"
.text
.globl standalone__channel_attn_se__vision_kernel
.p2align 8
.type standalone__channel_attn_se__vision_kernel,@function
standalone__channel_attn_se__vision_kernel:
    s_cmp_ge_u32 s2, 256
    s_cbranch_scc1 L_end
    s_load_dwordx4 s[4:7], s[0:1], 0
    s_load_dwordx4 s[8:11], s[0:1], 16
    s_load_dwordx4 s[12:15], s[0:1], 32
    v_lshrrev_b32 v10, 6, v0
    v_lshlrev_b32 v1, 4, v0
    v_readfirstlane_b32 s20, v10
    s_mul_i32 s3, s2, 196608
    s_and_b32 s22, s2, 7
    s_mul_i32 s22, s22, 1536
    s_mov_b32 s21, 0
    s_waitcnt lgkmcnt(0)
    s_add_u32 s16, s4, s3
    s_addc_u32 s17, s5, 0
    s_add_u32 s18, s10, s3
    s_addc_u32 s19, s11, 0
    s_add_u32 s24, s14, s22
    s_addc_u32 s25, s15, 0
    s_cmp_lg_u32 s2, 0
    s_cbranch_scc1 L_nozero
    s_cmp_lg_u32 s20, 11
    s_cbranch_scc1 L_nozero
    v_mov_b32 v10, 0
    v_mov_b32 v11, 0
    v_mov_b32 v12, 0
    v_mov_b32 v13, 0
    v_and_b32 v14, 63, v0
    v_lshlrev_b32 v14, 4, v14
    global_store_dwordx4 v14, v[10:13], s[14:15] offset:0 sc1
    global_store_dwordx4 v14, v[10:13], s[14:15] offset:1024 sc1
    global_store_dwordx4 v14, v[10:13], s[14:15] offset:2048 sc1
    global_store_dwordx4 v14, v[10:13], s[14:15] offset:3072 sc1
    v_add_u32 v14, 4096, v14
    global_store_dwordx4 v14, v[10:13], s[14:15] offset:0 sc1
    global_store_dwordx4 v14, v[10:13], s[14:15] offset:1024 sc1
    global_store_dwordx4 v14, v[10:13], s[14:15] offset:2048 sc1
    global_store_dwordx4 v14, v[10:13], s[14:15] offset:3072 sc1
    v_add_u32 v14, 4096, v14
    global_store_dwordx4 v14, v[10:13], s[14:15] offset:0 sc1
    global_store_dwordx4 v14, v[10:13], s[14:15] offset:1024 sc1
    global_store_dwordx4 v14, v[10:13], s[14:15] offset:2048 sc1
    global_store_dwordx4 v14, v[10:13], s[14:15] offset:3072 sc1
    s_waitcnt vmcnt(0)
    v_mov_b32 v10, 1
    v_mov_b32 v14, 0
    global_store_dword v14, v10, s[12:13] sc1
L_nozero:
    global_load_dwordx4 v[16:19], v1, s[16:17]
    s_add_u32 s16, s16, 12288
    s_addc_u32 s17, s17, 0
    global_load_dwordx4 v[20:23], v1, s[16:17]
    s_add_u32 s16, s16, 12288
    s_addc_u32 s17, s17, 0
    global_load_dwordx4 v[24:27], v1, s[16:17]
    s_add_u32 s16, s16, 12288
    s_addc_u32 s17, s17, 0
    global_load_dwordx4 v[28:31], v1, s[16:17]
    s_add_u32 s16, s16, 12288
    s_addc_u32 s17, s17, 0
    global_load_dwordx4 v[32:35], v1, s[16:17]
    s_add_u32 s16, s16, 12288
    s_addc_u32 s17, s17, 0
    global_load_dwordx4 v[36:39], v1, s[16:17]
    s_add_u32 s16, s16, 12288
    s_addc_u32 s17, s17, 0
    global_load_dwordx4 v[40:43], v1, s[16:17]
    s_add_u32 s16, s16, 12288
    s_addc_u32 s17, s17, 0
    global_load_dwordx4 v[44:47], v1, s[16:17]
    s_add_u32 s16, s16, 12288
    s_addc_u32 s17, s17, 0
    global_load_dwordx4 v[48:51], v1, s[16:17]
    s_add_u32 s16, s16, 12288
    s_addc_u32 s17, s17, 0
    global_load_dwordx4 v[52:55], v1, s[16:17]
    s_add_u32 s16, s16, 12288
    s_addc_u32 s17, s17, 0
    global_load_dwordx4 v[56:59], v1, s[16:17]
    s_add_u32 s16, s16, 12288
    s_addc_u32 s17, s17, 0
    global_load_dwordx4 v[60:63], v1, s[16:17]
    s_add_u32 s16, s16, 12288
    s_addc_u32 s17, s17, 0
    global_load_dwordx4 v[64:67], v1, s[16:17]
    s_add_u32 s16, s16, 12288
    s_addc_u32 s17, s17, 0
    global_load_dwordx4 v[68:71], v1, s[16:17]
    s_add_u32 s16, s16, 12288
    s_addc_u32 s17, s17, 0
    global_load_dwordx4 v[72:75], v1, s[16:17]
    s_add_u32 s16, s16, 12288
    s_addc_u32 s17, s17, 0
    global_load_dwordx4 v[76:79], v1, s[16:17]
    v_mul_u32_u24 v10, 2731, v0
    v_lshrrev_b32 v10, 16, v10
    v_mul_u32_u24 v11, 24, v10
    v_sub_u32 v11, v0, v11
    v_mul_u32_u24 v124, 576, v10
    v_lshl_add_u32 v124, v11, 1, v124
    v_mul_u32_u24 v127, 48, v10
    v_lshlrev_b32 v126, 2, v11
    global_load_ushort v80, v124, s[6:7] offset:0
    global_load_ushort v81, v124, s[6:7] offset:48
    global_load_ushort v82, v124, s[6:7] offset:96
    global_load_ushort v83, v124, s[6:7] offset:144
    global_load_ushort v84, v124, s[6:7] offset:192
    global_load_ushort v85, v124, s[6:7] offset:240
    global_load_ushort v86, v124, s[6:7] offset:288
    global_load_ushort v87, v124, s[6:7] offset:336
    global_load_ushort v88, v124, s[6:7] offset:384
    global_load_ushort v89, v124, s[6:7] offset:432
    global_load_ushort v90, v124, s[6:7] offset:480
    global_load_ushort v91, v124, s[6:7] offset:528
    v_subrev_u32 v125, 384, v0
    v_cmp_gt_u32 vcc, 384, v0
    s_nop 1
    v_cndmask_b32 v125, v125, v0, vcc
    v_lshlrev_b32 v125, 1, v125
    global_load_ushort v92, v125, s[8:9] offset:0
    global_load_ushort v93, v125, s[8:9] offset:768
    global_load_ushort v94, v125, s[8:9] offset:1536
    global_load_ushort v95, v125, s[8:9] offset:2304
    global_load_ushort v96, v125, s[8:9] offset:3072
    v_add_u32 v125, 3840, v125
    global_load_ushort v97, v125, s[8:9] offset:0
    global_load_ushort v98, v125, s[8:9] offset:768
    global_load_ushort v99, v125, s[8:9] offset:1536
    global_load_ushort v100, v125, s[8:9] offset:2304
    global_load_ushort v101, v125, s[8:9] offset:3072
    v_add_u32 v125, 3840, v125
    global_load_ushort v102, v125, s[8:9] offset:0
    global_load_ushort v103, v125, s[8:9] offset:768
    global_load_ushort v104, v125, s[8:9] offset:1536
    global_load_ushort v105, v125, s[8:9] offset:2304
    global_load_ushort v106, v125, s[8:9] offset:3072
    v_add_u32 v125, 3840, v125
    global_load_ushort v107, v125, s[8:9] offset:0
    global_load_ushort v108, v125, s[8:9] offset:768
    global_load_ushort v109, v125, s[8:9] offset:1536
    global_load_ushort v110, v125, s[8:9] offset:2304
    global_load_ushort v111, v125, s[8:9] offset:3072
    v_add_u32 v125, 3840, v125
    global_load_ushort v112, v125, s[8:9] offset:0
    global_load_ushort v113, v125, s[8:9] offset:768
    global_load_ushort v114, v125, s[8:9] offset:1536
    global_load_ushort v115, v125, s[8:9] offset:2304
    v_and_b32 v10, 31, v0
    v_lshlrev_b32 v10, 2, v10
    v_mov_b32 v11, 0
    ds_write_b32 v10, v11 offset:26112
    v_mov_b32 v2, 0
    v_mov_b32 v3, 0
    v_mov_b32 v4, 0
    v_mov_b32 v5, 0
    v_mov_b32 v6, 0
    v_mov_b32 v7, 0
    v_mov_b32 v8, 0
    v_mov_b32 v9, 0
    s_waitcnt vmcnt(51)
    v_lshlrev_b32 v10, 16, v16
    v_and_b32 v11, 0xffff0000, v16
    v_add_f32 v2, v2, v10
    v_add_f32 v3, v3, v11
    v_lshlrev_b32 v10, 16, v17
    v_and_b32 v11, 0xffff0000, v17
    v_add_f32 v4, v4, v10
    v_add_f32 v5, v5, v11
    v_lshlrev_b32 v10, 16, v18
    v_and_b32 v11, 0xffff0000, v18
    v_add_f32 v6, v6, v10
    v_add_f32 v7, v7, v11
    v_lshlrev_b32 v10, 16, v19
    v_and_b32 v11, 0xffff0000, v19
    v_add_f32 v8, v8, v10
    v_add_f32 v9, v9, v11
    s_waitcnt vmcnt(50)
    v_lshlrev_b32 v10, 16, v20
    v_and_b32 v11, 0xffff0000, v20
    v_add_f32 v2, v2, v10
    v_add_f32 v3, v3, v11
    v_lshlrev_b32 v10, 16, v21
    v_and_b32 v11, 0xffff0000, v21
    v_add_f32 v4, v4, v10
    v_add_f32 v5, v5, v11
    v_lshlrev_b32 v10, 16, v22
    v_and_b32 v11, 0xffff0000, v22
    v_add_f32 v6, v6, v10
    v_add_f32 v7, v7, v11
    v_lshlrev_b32 v10, 16, v23
    v_and_b32 v11, 0xffff0000, v23
    v_add_f32 v8, v8, v10
    v_add_f32 v9, v9, v11
    s_waitcnt vmcnt(49)
    v_lshlrev_b32 v10, 16, v24
    v_and_b32 v11, 0xffff0000, v24
    v_add_f32 v2, v2, v10
    v_add_f32 v3, v3, v11
    v_lshlrev_b32 v10, 16, v25
    v_and_b32 v11, 0xffff0000, v25
    v_add_f32 v4, v4, v10
    v_add_f32 v5, v5, v11
    v_lshlrev_b32 v10, 16, v26
    v_and_b32 v11, 0xffff0000, v26
    v_add_f32 v6, v6, v10
    v_add_f32 v7, v7, v11
    v_lshlrev_b32 v10, 16, v27
    v_and_b32 v11, 0xffff0000, v27
    v_add_f32 v8, v8, v10
    v_add_f32 v9, v9, v11
    s_waitcnt vmcnt(48)
    v_lshlrev_b32 v10, 16, v28
    v_and_b32 v11, 0xffff0000, v28
    v_add_f32 v2, v2, v10
    v_add_f32 v3, v3, v11
    v_lshlrev_b32 v10, 16, v29
    v_and_b32 v11, 0xffff0000, v29
    v_add_f32 v4, v4, v10
    v_add_f32 v5, v5, v11
    v_lshlrev_b32 v10, 16, v30
    v_and_b32 v11, 0xffff0000, v30
    v_add_f32 v6, v6, v10
    v_add_f32 v7, v7, v11
    v_lshlrev_b32 v10, 16, v31
    v_and_b32 v11, 0xffff0000, v31
    v_add_f32 v8, v8, v10
    v_add_f32 v9, v9, v11
    s_waitcnt vmcnt(47)
    v_lshlrev_b32 v10, 16, v32
    v_and_b32 v11, 0xffff0000, v32
    v_add_f32 v2, v2, v10
    v_add_f32 v3, v3, v11
    v_lshlrev_b32 v10, 16, v33
    v_and_b32 v11, 0xffff0000, v33
    v_add_f32 v4, v4, v10
    v_add_f32 v5, v5, v11
    v_lshlrev_b32 v10, 16, v34
    v_and_b32 v11, 0xffff0000, v34
    v_add_f32 v6, v6, v10
    v_add_f32 v7, v7, v11
    v_lshlrev_b32 v10, 16, v35
    v_and_b32 v11, 0xffff0000, v35
    v_add_f32 v8, v8, v10
    v_add_f32 v9, v9, v11
    s_waitcnt vmcnt(46)
    v_lshlrev_b32 v10, 16, v36
    v_and_b32 v11, 0xffff0000, v36
    v_add_f32 v2, v2, v10
    v_add_f32 v3, v3, v11
    v_lshlrev_b32 v10, 16, v37
    v_and_b32 v11, 0xffff0000, v37
    v_add_f32 v4, v4, v10
    v_add_f32 v5, v5, v11
    v_lshlrev_b32 v10, 16, v38
    v_and_b32 v11, 0xffff0000, v38
    v_add_f32 v6, v6, v10
    v_add_f32 v7, v7, v11
    v_lshlrev_b32 v10, 16, v39
    v_and_b32 v11, 0xffff0000, v39
    v_add_f32 v8, v8, v10
    v_add_f32 v9, v9, v11
    s_waitcnt vmcnt(45)
    v_lshlrev_b32 v10, 16, v40
    v_and_b32 v11, 0xffff0000, v40
    v_add_f32 v2, v2, v10
    v_add_f32 v3, v3, v11
    v_lshlrev_b32 v10, 16, v41
    v_and_b32 v11, 0xffff0000, v41
    v_add_f32 v4, v4, v10
    v_add_f32 v5, v5, v11
    v_lshlrev_b32 v10, 16, v42
    v_and_b32 v11, 0xffff0000, v42
    v_add_f32 v6, v6, v10
    v_add_f32 v7, v7, v11
    v_lshlrev_b32 v10, 16, v43
    v_and_b32 v11, 0xffff0000, v43
    v_add_f32 v8, v8, v10
    v_add_f32 v9, v9, v11
    s_waitcnt vmcnt(44)
    v_lshlrev_b32 v10, 16, v44
    v_and_b32 v11, 0xffff0000, v44
    v_add_f32 v2, v2, v10
    v_add_f32 v3, v3, v11
    v_lshlrev_b32 v10, 16, v45
    v_and_b32 v11, 0xffff0000, v45
    v_add_f32 v4, v4, v10
    v_add_f32 v5, v5, v11
    v_lshlrev_b32 v10, 16, v46
    v_and_b32 v11, 0xffff0000, v46
    v_add_f32 v6, v6, v10
    v_add_f32 v7, v7, v11
    v_lshlrev_b32 v10, 16, v47
    v_and_b32 v11, 0xffff0000, v47
    v_add_f32 v8, v8, v10
    v_add_f32 v9, v9, v11
    s_waitcnt vmcnt(43)
    v_lshlrev_b32 v10, 16, v48
    v_and_b32 v11, 0xffff0000, v48
    v_add_f32 v2, v2, v10
    v_add_f32 v3, v3, v11
    v_lshlrev_b32 v10, 16, v49
    v_and_b32 v11, 0xffff0000, v49
    v_add_f32 v4, v4, v10
    v_add_f32 v5, v5, v11
    v_lshlrev_b32 v10, 16, v50
    v_and_b32 v11, 0xffff0000, v50
    v_add_f32 v6, v6, v10
    v_add_f32 v7, v7, v11
    v_lshlrev_b32 v10, 16, v51
    v_and_b32 v11, 0xffff0000, v51
    v_add_f32 v8, v8, v10
    v_add_f32 v9, v9, v11
    s_waitcnt vmcnt(42)
    v_lshlrev_b32 v10, 16, v52
    v_and_b32 v11, 0xffff0000, v52
    v_add_f32 v2, v2, v10
    v_add_f32 v3, v3, v11
    v_lshlrev_b32 v10, 16, v53
    v_and_b32 v11, 0xffff0000, v53
    v_add_f32 v4, v4, v10
    v_add_f32 v5, v5, v11
    v_lshlrev_b32 v10, 16, v54
    v_and_b32 v11, 0xffff0000, v54
    v_add_f32 v6, v6, v10
    v_add_f32 v7, v7, v11
    v_lshlrev_b32 v10, 16, v55
    v_and_b32 v11, 0xffff0000, v55
    v_add_f32 v8, v8, v10
    v_add_f32 v9, v9, v11
    s_waitcnt vmcnt(41)
    v_lshlrev_b32 v10, 16, v56
    v_and_b32 v11, 0xffff0000, v56
    v_add_f32 v2, v2, v10
    v_add_f32 v3, v3, v11
    v_lshlrev_b32 v10, 16, v57
    v_and_b32 v11, 0xffff0000, v57
    v_add_f32 v4, v4, v10
    v_add_f32 v5, v5, v11
    v_lshlrev_b32 v10, 16, v58
    v_and_b32 v11, 0xffff0000, v58
    v_add_f32 v6, v6, v10
    v_add_f32 v7, v7, v11
    v_lshlrev_b32 v10, 16, v59
    v_and_b32 v11, 0xffff0000, v59
    v_add_f32 v8, v8, v10
    v_add_f32 v9, v9, v11
    s_waitcnt vmcnt(40)
    v_lshlrev_b32 v10, 16, v60
    v_and_b32 v11, 0xffff0000, v60
    v_add_f32 v2, v2, v10
    v_add_f32 v3, v3, v11
    v_lshlrev_b32 v10, 16, v61
    v_and_b32 v11, 0xffff0000, v61
    v_add_f32 v4, v4, v10
    v_add_f32 v5, v5, v11
    v_lshlrev_b32 v10, 16, v62
    v_and_b32 v11, 0xffff0000, v62
    v_add_f32 v6, v6, v10
    v_add_f32 v7, v7, v11
    v_lshlrev_b32 v10, 16, v63
    v_and_b32 v11, 0xffff0000, v63
    v_add_f32 v8, v8, v10
    v_add_f32 v9, v9, v11
    s_waitcnt vmcnt(39)
    v_lshlrev_b32 v10, 16, v64
    v_and_b32 v11, 0xffff0000, v64
    v_add_f32 v2, v2, v10
    v_add_f32 v3, v3, v11
    v_lshlrev_b32 v10, 16, v65
    v_and_b32 v11, 0xffff0000, v65
    v_add_f32 v4, v4, v10
    v_add_f32 v5, v5, v11
    v_lshlrev_b32 v10, 16, v66
    v_and_b32 v11, 0xffff0000, v66
    v_add_f32 v6, v6, v10
    v_add_f32 v7, v7, v11
    v_lshlrev_b32 v10, 16, v67
    v_and_b32 v11, 0xffff0000, v67
    v_add_f32 v8, v8, v10
    v_add_f32 v9, v9, v11
    s_waitcnt vmcnt(38)
    v_lshlrev_b32 v10, 16, v68
    v_and_b32 v11, 0xffff0000, v68
    v_add_f32 v2, v2, v10
    v_add_f32 v3, v3, v11
    v_lshlrev_b32 v10, 16, v69
    v_and_b32 v11, 0xffff0000, v69
    v_add_f32 v4, v4, v10
    v_add_f32 v5, v5, v11
    v_lshlrev_b32 v10, 16, v70
    v_and_b32 v11, 0xffff0000, v70
    v_add_f32 v6, v6, v10
    v_add_f32 v7, v7, v11
    v_lshlrev_b32 v10, 16, v71
    v_and_b32 v11, 0xffff0000, v71
    v_add_f32 v8, v8, v10
    v_add_f32 v9, v9, v11
    s_waitcnt vmcnt(37)
    v_lshlrev_b32 v10, 16, v72
    v_and_b32 v11, 0xffff0000, v72
    v_add_f32 v2, v2, v10
    v_add_f32 v3, v3, v11
    v_lshlrev_b32 v10, 16, v73
    v_and_b32 v11, 0xffff0000, v73
    v_add_f32 v4, v4, v10
    v_add_f32 v5, v5, v11
    v_lshlrev_b32 v10, 16, v74
    v_and_b32 v11, 0xffff0000, v74
    v_add_f32 v6, v6, v10
    v_add_f32 v7, v7, v11
    v_lshlrev_b32 v10, 16, v75
    v_and_b32 v11, 0xffff0000, v75
    v_add_f32 v8, v8, v10
    v_add_f32 v9, v9, v11
    s_waitcnt vmcnt(36)
    v_lshlrev_b32 v10, 16, v76
    v_and_b32 v11, 0xffff0000, v76
    v_add_f32 v2, v2, v10
    v_add_f32 v3, v3, v11
    v_lshlrev_b32 v10, 16, v77
    v_and_b32 v11, 0xffff0000, v77
    v_add_f32 v4, v4, v10
    v_add_f32 v5, v5, v11
    v_lshlrev_b32 v10, 16, v78
    v_and_b32 v11, 0xffff0000, v78
    v_add_f32 v6, v6, v10
    v_add_f32 v7, v7, v11
    v_lshlrev_b32 v10, 16, v79
    v_and_b32 v11, 0xffff0000, v79
    v_add_f32 v8, v8, v10
    v_add_f32 v9, v9, v11
    v_lshlrev_b32 v10, 5, v0
    ds_write_b128 v10, v[2:5] offset:0
    ds_write_b128 v10, v[6:9] offset:16
    s_cmp_lg_u32 s20, 0
    s_cbranch_scc1 L_flag_ok
    v_mov_b32 v14, 0
L_flag:
    global_load_dword v10, v14, s[12:13] sc1
    s_waitcnt vmcnt(0)
    v_readfirstlane_b32 s22, v10
    s_cmp_lg_u32 s22, 0
    s_cbranch_scc1 L_flag_ok
    s_sleep 1
    s_add_u32 s21, s21, 1
    s_cmp_lt_u32 s21, 200000
    s_cbranch_scc1 L_flag
L_flag_ok:
    s_waitcnt lgkmcnt(0)
    s_barrier
    s_cmp_ge_u32 s20, 6
    s_cbranch_scc1 L_skip_atomic
    v_lshlrev_b32 v14, 2, v0
    ds_read_b32 v116, v14 offset:0
    ds_read_b32 v117, v14 offset:1536
    ds_read_b32 v118, v14 offset:3072
    ds_read_b32 v119, v14 offset:4608
    ds_read_b32 v120, v14 offset:6144
    ds_read_b32 v121, v14 offset:7680
    ds_read_b32 v122, v14 offset:9216
    ds_read_b32 v123, v14 offset:10752
    ds_read_b32 v10, v14 offset:12288
    ds_read_b32 v11, v14 offset:13824
    ds_read_b32 v12, v14 offset:15360
    ds_read_b32 v13, v14 offset:16896
    ds_read_b32 v2, v14 offset:18432
    ds_read_b32 v3, v14 offset:19968
    ds_read_b32 v4, v14 offset:21504
    ds_read_b32 v5, v14 offset:23040
    s_waitcnt lgkmcnt(0)
    v_add_f32 v116, v116, v117
    v_add_f32 v118, v118, v119
    v_add_f32 v120, v120, v121
    v_add_f32 v122, v122, v123
    v_add_f32 v10, v10, v11
    v_add_f32 v12, v12, v13
    v_add_f32 v2, v2, v3
    v_add_f32 v4, v4, v5
    v_add_f32 v116, v116, v118
    v_add_f32 v120, v120, v122
    v_add_f32 v10, v10, v12
    v_add_f32 v2, v2, v4
    v_add_f32 v116, v116, v120
    v_add_f32 v10, v10, v2
    v_add_f32 v116, v116, v10
    global_atomic_add_f32 v14, v116, s[24:25]
    s_waitcnt vmcnt(0)
L_skip_atomic:
    s_barrier
    s_cmp_lg_u32 s20, 0
    s_cbranch_scc1 L_arrived
    v_mov_b32 v14, 0
    v_mov_b32 v10, 1
    s_mov_b64 s[28:29], exec
    s_mov_b64 exec, 1
    global_atomic_add v14, v10, s[12:13] offset:128
    s_mov_b64 exec, s[28:29]
L_poll:
    global_load_dword v10, v14, s[12:13] offset:128 sc1
    s_waitcnt vmcnt(0)
    v_readfirstlane_b32 s22, v10
    s_cmp_ge_u32 s22, 256
    s_cbranch_scc1 L_arrived
    s_sleep 1
    s_add_u32 s21, s21, 1
    s_cmp_lt_u32 s21, 200000
    s_cbranch_scc1 L_poll
L_arrived:
    s_barrier
    s_cmp_ge_u32 s20, 6
    s_cbranch_scc1 L_skip_mean
    v_lshlrev_b32 v14, 2, v0
    global_load_dword v116, v14, s[14:15] offset:0 sc1
    global_load_dword v117, v14, s[14:15] offset:1536 sc1
    v_add_u32 v14, 3072, v14
    global_load_dword v118, v14, s[14:15] offset:0 sc1
    global_load_dword v119, v14, s[14:15] offset:1536 sc1
    v_add_u32 v14, 3072, v14
    global_load_dword v120, v14, s[14:15] offset:0 sc1
    global_load_dword v121, v14, s[14:15] offset:1536 sc1
    v_add_u32 v14, 3072, v14
    global_load_dword v122, v14, s[14:15] offset:0 sc1
    global_load_dword v123, v14, s[14:15] offset:1536 sc1
    s_waitcnt vmcnt(0)
    v_add_f32 v116, v116, v117
    v_add_f32 v118, v118, v119
    v_add_f32 v120, v120, v121
    v_add_f32 v122, v122, v123
    v_add_f32 v116, v116, v118
    v_add_f32 v120, v120, v122
    v_add_f32 v116, v116, v120
    v_mul_f32 v10, 0x37800000, v116
    v_cvt_pk_bf16_f32 v10, v10, v10
    v_lshlrev_b32 v10, 16, v10
    v_lshlrev_b32 v14, 2, v0
    ds_write_b32 v14, v10 offset:24576
    s_waitcnt lgkmcnt(0)
L_skip_mean:
    s_barrier
    ds_read_b128 v[116:119], v127 offset:24576
    ds_read_b128 v[120:123], v127 offset:24592
    ds_read_b128 v[10:13], v127 offset:24608
    v_lshlrev_b32 v80, 16, v80
    v_lshlrev_b32 v81, 16, v81
    v_lshlrev_b32 v82, 16, v82
    v_lshlrev_b32 v83, 16, v83
    v_lshlrev_b32 v84, 16, v84
    v_lshlrev_b32 v85, 16, v85
    v_lshlrev_b32 v86, 16, v86
    v_lshlrev_b32 v87, 16, v87
    v_lshlrev_b32 v88, 16, v88
    v_lshlrev_b32 v89, 16, v89
    v_lshlrev_b32 v90, 16, v90
    v_lshlrev_b32 v91, 16, v91
    v_lshlrev_b32 v92, 16, v92
    v_lshlrev_b32 v93, 16, v93
    v_lshlrev_b32 v94, 16, v94
    v_lshlrev_b32 v95, 16, v95
    v_lshlrev_b32 v96, 16, v96
    v_lshlrev_b32 v97, 16, v97
    v_lshlrev_b32 v98, 16, v98
    v_lshlrev_b32 v99, 16, v99
    v_lshlrev_b32 v100, 16, v100
    v_lshlrev_b32 v101, 16, v101
    v_lshlrev_b32 v102, 16, v102
    v_lshlrev_b32 v103, 16, v103
    v_lshlrev_b32 v104, 16, v104
    v_lshlrev_b32 v105, 16, v105
    v_lshlrev_b32 v106, 16, v106
    v_lshlrev_b32 v107, 16, v107
    v_lshlrev_b32 v108, 16, v108
    v_lshlrev_b32 v109, 16, v109
    v_lshlrev_b32 v110, 16, v110
    v_lshlrev_b32 v111, 16, v111
    v_lshlrev_b32 v112, 16, v112
    v_lshlrev_b32 v113, 16, v113
    v_lshlrev_b32 v114, 16, v114
    v_lshlrev_b32 v115, 16, v115
    s_waitcnt lgkmcnt(0)
    v_mul_f32 v14, v116, v80
    v_fmac_f32 v14, v117, v81
    v_fmac_f32 v14, v118, v82
    v_fmac_f32 v14, v119, v83
    v_fmac_f32 v14, v120, v84
    v_fmac_f32 v14, v121, v85
    v_fmac_f32 v14, v122, v86
    v_fmac_f32 v14, v123, v87
    v_fmac_f32 v14, v10, v88
    v_fmac_f32 v14, v11, v89
    v_fmac_f32 v14, v12, v90
    v_fmac_f32 v14, v13, v91
    ds_add_f32 v126, v14 offset:26112
    s_waitcnt lgkmcnt(0)
    s_barrier
    v_and_b32 v10, 31, v0
    v_lshlrev_b32 v10, 2, v10
    ds_read_b32 v10, v10 offset:26112
    s_waitcnt lgkmcnt(0)
    v_cvt_pk_bf16_f32 v10, v10, v10
    v_lshlrev_b32 v10, 16, v10
    v_mul_f32 v11, 0xbfb8aa3b, v10
    v_exp_f32 v11, v11
    s_nop 0
    v_add_f32 v11, 1.0, v11
    v_rcp_f32 v11, v11
    s_nop 0
    v_mul_f32 v10, v10, v11
    v_cvt_pk_bf16_f32 v10, v10, v10
    v_lshlrev_b32 v10, 16, v10
    s_nop 0
    v_readlane_b32 s40, v10, 0
    v_readlane_b32 s41, v10, 1
    v_readlane_b32 s42, v10, 2
    v_readlane_b32 s43, v10, 3
    v_readlane_b32 s44, v10, 4
    v_readlane_b32 s45, v10, 5
    v_readlane_b32 s46, v10, 6
    v_readlane_b32 s47, v10, 7
    v_readlane_b32 s48, v10, 8
    v_readlane_b32 s49, v10, 9
    v_readlane_b32 s50, v10, 10
    v_readlane_b32 s51, v10, 11
    v_readlane_b32 s52, v10, 12
    v_readlane_b32 s53, v10, 13
    v_readlane_b32 s54, v10, 14
    v_readlane_b32 s55, v10, 15
    v_readlane_b32 s56, v10, 16
    v_readlane_b32 s57, v10, 17
    v_readlane_b32 s58, v10, 18
    v_readlane_b32 s59, v10, 19
    v_readlane_b32 s60, v10, 20
    v_readlane_b32 s61, v10, 21
    v_readlane_b32 s62, v10, 22
    v_readlane_b32 s63, v10, 23
    s_nop 1
    v_mul_f32 v14, s40, v92
    v_fmac_f32 v14, s41, v93
    v_fmac_f32 v14, s42, v94
    v_fmac_f32 v14, s43, v95
    v_fmac_f32 v14, s44, v96
    v_fmac_f32 v14, s45, v97
    v_fmac_f32 v14, s46, v98
    v_fmac_f32 v14, s47, v99
    v_fmac_f32 v14, s48, v100
    v_fmac_f32 v14, s49, v101
    v_fmac_f32 v14, s50, v102
    v_fmac_f32 v14, s51, v103
    v_fmac_f32 v14, s52, v104
    v_fmac_f32 v14, s53, v105
    v_fmac_f32 v14, s54, v106
    v_fmac_f32 v14, s55, v107
    v_fmac_f32 v14, s56, v108
    v_fmac_f32 v14, s57, v109
    v_fmac_f32 v14, s58, v110
    v_fmac_f32 v14, s59, v111
    v_fmac_f32 v14, s60, v112
    v_fmac_f32 v14, s61, v113
    v_fmac_f32 v14, s62, v114
    v_fmac_f32 v14, s63, v115
    v_cvt_pk_bf16_f32 v14, v14, v14
    v_lshlrev_b32 v14, 16, v14
    v_mul_f32 v11, 0xbfb8aa3b, v14
    v_exp_f32 v11, v11
    s_nop 0
    v_add_f32 v11, 1.0, v11
    v_rcp_f32 v11, v11
    s_nop 0
    v_cvt_pk_bf16_f32 v11, v11, v11
    v_lshlrev_b32 v11, 16, v11
    v_subrev_u32 v10, 384, v0
    v_cmp_gt_u32 vcc, 384, v0
    s_nop 1
    v_cndmask_b32 v10, v10, v0, vcc
    v_lshlrev_b32 v10, 2, v10
    ds_write_b32 v10, v11 offset:26240
    s_waitcnt lgkmcnt(0)
    s_barrier
    v_mul_u32_u24 v10, 1366, v0
    v_lshrrev_b32 v10, 16, v10
    v_mul_u32_u24 v10, 48, v10
    v_sub_u32 v10, v0, v10
    v_lshlrev_b32 v10, 5, v10
    ds_read_b128 v[116:119], v10 offset:26240
    ds_read_b128 v[120:123], v10 offset:26256
    s_waitcnt lgkmcnt(0)
    v_lshlrev_b32 v10, 16, v16
    v_and_b32 v11, 0xffff0000, v16
    v_mul_f32 v10, v10, v116
    v_mul_f32 v11, v11, v117
    v_cvt_pk_bf16_f32 v16, v10, v11
    v_lshlrev_b32 v10, 16, v17
    v_and_b32 v11, 0xffff0000, v17
    v_mul_f32 v10, v10, v118
    v_mul_f32 v11, v11, v119
    v_cvt_pk_bf16_f32 v17, v10, v11
    v_lshlrev_b32 v10, 16, v18
    v_and_b32 v11, 0xffff0000, v18
    v_mul_f32 v10, v10, v120
    v_mul_f32 v11, v11, v121
    v_cvt_pk_bf16_f32 v18, v10, v11
    v_lshlrev_b32 v10, 16, v19
    v_and_b32 v11, 0xffff0000, v19
    v_mul_f32 v10, v10, v122
    v_mul_f32 v11, v11, v123
    v_cvt_pk_bf16_f32 v19, v10, v11
    global_store_dwordx4 v1, v[16:19], s[18:19]
    s_add_u32 s18, s18, 12288
    s_addc_u32 s19, s19, 0
    v_lshlrev_b32 v10, 16, v20
    v_and_b32 v11, 0xffff0000, v20
    v_mul_f32 v10, v10, v116
    v_mul_f32 v11, v11, v117
    v_cvt_pk_bf16_f32 v20, v10, v11
    v_lshlrev_b32 v10, 16, v21
    v_and_b32 v11, 0xffff0000, v21
    v_mul_f32 v10, v10, v118
    v_mul_f32 v11, v11, v119
    v_cvt_pk_bf16_f32 v21, v10, v11
    v_lshlrev_b32 v10, 16, v22
    v_and_b32 v11, 0xffff0000, v22
    v_mul_f32 v10, v10, v120
    v_mul_f32 v11, v11, v121
    v_cvt_pk_bf16_f32 v22, v10, v11
    v_lshlrev_b32 v10, 16, v23
    v_and_b32 v11, 0xffff0000, v23
    v_mul_f32 v10, v10, v122
    v_mul_f32 v11, v11, v123
    v_cvt_pk_bf16_f32 v23, v10, v11
    global_store_dwordx4 v1, v[20:23], s[18:19]
    s_add_u32 s18, s18, 12288
    s_addc_u32 s19, s19, 0
    v_lshlrev_b32 v10, 16, v24
    v_and_b32 v11, 0xffff0000, v24
    v_mul_f32 v10, v10, v116
    v_mul_f32 v11, v11, v117
    v_cvt_pk_bf16_f32 v24, v10, v11
    v_lshlrev_b32 v10, 16, v25
    v_and_b32 v11, 0xffff0000, v25
    v_mul_f32 v10, v10, v118
    v_mul_f32 v11, v11, v119
    v_cvt_pk_bf16_f32 v25, v10, v11
    v_lshlrev_b32 v10, 16, v26
    v_and_b32 v11, 0xffff0000, v26
    v_mul_f32 v10, v10, v120
    v_mul_f32 v11, v11, v121
    v_cvt_pk_bf16_f32 v26, v10, v11
    v_lshlrev_b32 v10, 16, v27
    v_and_b32 v11, 0xffff0000, v27
    v_mul_f32 v10, v10, v122
    v_mul_f32 v11, v11, v123
    v_cvt_pk_bf16_f32 v27, v10, v11
    global_store_dwordx4 v1, v[24:27], s[18:19]
    s_add_u32 s18, s18, 12288
    s_addc_u32 s19, s19, 0
    v_lshlrev_b32 v10, 16, v28
    v_and_b32 v11, 0xffff0000, v28
    v_mul_f32 v10, v10, v116
    v_mul_f32 v11, v11, v117
    v_cvt_pk_bf16_f32 v28, v10, v11
    v_lshlrev_b32 v10, 16, v29
    v_and_b32 v11, 0xffff0000, v29
    v_mul_f32 v10, v10, v118
    v_mul_f32 v11, v11, v119
    v_cvt_pk_bf16_f32 v29, v10, v11
    v_lshlrev_b32 v10, 16, v30
    v_and_b32 v11, 0xffff0000, v30
    v_mul_f32 v10, v10, v120
    v_mul_f32 v11, v11, v121
    v_cvt_pk_bf16_f32 v30, v10, v11
    v_lshlrev_b32 v10, 16, v31
    v_and_b32 v11, 0xffff0000, v31
    v_mul_f32 v10, v10, v122
    v_mul_f32 v11, v11, v123
    v_cvt_pk_bf16_f32 v31, v10, v11
    global_store_dwordx4 v1, v[28:31], s[18:19]
    s_add_u32 s18, s18, 12288
    s_addc_u32 s19, s19, 0
    v_lshlrev_b32 v10, 16, v32
    v_and_b32 v11, 0xffff0000, v32
    v_mul_f32 v10, v10, v116
    v_mul_f32 v11, v11, v117
    v_cvt_pk_bf16_f32 v32, v10, v11
    v_lshlrev_b32 v10, 16, v33
    v_and_b32 v11, 0xffff0000, v33
    v_mul_f32 v10, v10, v118
    v_mul_f32 v11, v11, v119
    v_cvt_pk_bf16_f32 v33, v10, v11
    v_lshlrev_b32 v10, 16, v34
    v_and_b32 v11, 0xffff0000, v34
    v_mul_f32 v10, v10, v120
    v_mul_f32 v11, v11, v121
    v_cvt_pk_bf16_f32 v34, v10, v11
    v_lshlrev_b32 v10, 16, v35
    v_and_b32 v11, 0xffff0000, v35
    v_mul_f32 v10, v10, v122
    v_mul_f32 v11, v11, v123
    v_cvt_pk_bf16_f32 v35, v10, v11
    global_store_dwordx4 v1, v[32:35], s[18:19]
    s_add_u32 s18, s18, 12288
    s_addc_u32 s19, s19, 0
    v_lshlrev_b32 v10, 16, v36
    v_and_b32 v11, 0xffff0000, v36
    v_mul_f32 v10, v10, v116
    v_mul_f32 v11, v11, v117
    v_cvt_pk_bf16_f32 v36, v10, v11
    v_lshlrev_b32 v10, 16, v37
    v_and_b32 v11, 0xffff0000, v37
    v_mul_f32 v10, v10, v118
    v_mul_f32 v11, v11, v119
    v_cvt_pk_bf16_f32 v37, v10, v11
    v_lshlrev_b32 v10, 16, v38
    v_and_b32 v11, 0xffff0000, v38
    v_mul_f32 v10, v10, v120
    v_mul_f32 v11, v11, v121
    v_cvt_pk_bf16_f32 v38, v10, v11
    v_lshlrev_b32 v10, 16, v39
    v_and_b32 v11, 0xffff0000, v39
    v_mul_f32 v10, v10, v122
    v_mul_f32 v11, v11, v123
    v_cvt_pk_bf16_f32 v39, v10, v11
    global_store_dwordx4 v1, v[36:39], s[18:19]
    s_add_u32 s18, s18, 12288
    s_addc_u32 s19, s19, 0
    v_lshlrev_b32 v10, 16, v40
    v_and_b32 v11, 0xffff0000, v40
    v_mul_f32 v10, v10, v116
    v_mul_f32 v11, v11, v117
    v_cvt_pk_bf16_f32 v40, v10, v11
    v_lshlrev_b32 v10, 16, v41
    v_and_b32 v11, 0xffff0000, v41
    v_mul_f32 v10, v10, v118
    v_mul_f32 v11, v11, v119
    v_cvt_pk_bf16_f32 v41, v10, v11
    v_lshlrev_b32 v10, 16, v42
    v_and_b32 v11, 0xffff0000, v42
    v_mul_f32 v10, v10, v120
    v_mul_f32 v11, v11, v121
    v_cvt_pk_bf16_f32 v42, v10, v11
    v_lshlrev_b32 v10, 16, v43
    v_and_b32 v11, 0xffff0000, v43
    v_mul_f32 v10, v10, v122
    v_mul_f32 v11, v11, v123
    v_cvt_pk_bf16_f32 v43, v10, v11
    global_store_dwordx4 v1, v[40:43], s[18:19]
    s_add_u32 s18, s18, 12288
    s_addc_u32 s19, s19, 0
    v_lshlrev_b32 v10, 16, v44
    v_and_b32 v11, 0xffff0000, v44
    v_mul_f32 v10, v10, v116
    v_mul_f32 v11, v11, v117
    v_cvt_pk_bf16_f32 v44, v10, v11
    v_lshlrev_b32 v10, 16, v45
    v_and_b32 v11, 0xffff0000, v45
    v_mul_f32 v10, v10, v118
    v_mul_f32 v11, v11, v119
    v_cvt_pk_bf16_f32 v45, v10, v11
    v_lshlrev_b32 v10, 16, v46
    v_and_b32 v11, 0xffff0000, v46
    v_mul_f32 v10, v10, v120
    v_mul_f32 v11, v11, v121
    v_cvt_pk_bf16_f32 v46, v10, v11
    v_lshlrev_b32 v10, 16, v47
    v_and_b32 v11, 0xffff0000, v47
    v_mul_f32 v10, v10, v122
    v_mul_f32 v11, v11, v123
    v_cvt_pk_bf16_f32 v47, v10, v11
    global_store_dwordx4 v1, v[44:47], s[18:19]
    s_add_u32 s18, s18, 12288
    s_addc_u32 s19, s19, 0
    v_lshlrev_b32 v10, 16, v48
    v_and_b32 v11, 0xffff0000, v48
    v_mul_f32 v10, v10, v116
    v_mul_f32 v11, v11, v117
    v_cvt_pk_bf16_f32 v48, v10, v11
    v_lshlrev_b32 v10, 16, v49
    v_and_b32 v11, 0xffff0000, v49
    v_mul_f32 v10, v10, v118
    v_mul_f32 v11, v11, v119
    v_cvt_pk_bf16_f32 v49, v10, v11
    v_lshlrev_b32 v10, 16, v50
    v_and_b32 v11, 0xffff0000, v50
    v_mul_f32 v10, v10, v120
    v_mul_f32 v11, v11, v121
    v_cvt_pk_bf16_f32 v50, v10, v11
    v_lshlrev_b32 v10, 16, v51
    v_and_b32 v11, 0xffff0000, v51
    v_mul_f32 v10, v10, v122
    v_mul_f32 v11, v11, v123
    v_cvt_pk_bf16_f32 v51, v10, v11
    global_store_dwordx4 v1, v[48:51], s[18:19]
    s_add_u32 s18, s18, 12288
    s_addc_u32 s19, s19, 0
    v_lshlrev_b32 v10, 16, v52
    v_and_b32 v11, 0xffff0000, v52
    v_mul_f32 v10, v10, v116
    v_mul_f32 v11, v11, v117
    v_cvt_pk_bf16_f32 v52, v10, v11
    v_lshlrev_b32 v10, 16, v53
    v_and_b32 v11, 0xffff0000, v53
    v_mul_f32 v10, v10, v118
    v_mul_f32 v11, v11, v119
    v_cvt_pk_bf16_f32 v53, v10, v11
    v_lshlrev_b32 v10, 16, v54
    v_and_b32 v11, 0xffff0000, v54
    v_mul_f32 v10, v10, v120
    v_mul_f32 v11, v11, v121
    v_cvt_pk_bf16_f32 v54, v10, v11
    v_lshlrev_b32 v10, 16, v55
    v_and_b32 v11, 0xffff0000, v55
    v_mul_f32 v10, v10, v122
    v_mul_f32 v11, v11, v123
    v_cvt_pk_bf16_f32 v55, v10, v11
    global_store_dwordx4 v1, v[52:55], s[18:19]
    s_add_u32 s18, s18, 12288
    s_addc_u32 s19, s19, 0
    v_lshlrev_b32 v10, 16, v56
    v_and_b32 v11, 0xffff0000, v56
    v_mul_f32 v10, v10, v116
    v_mul_f32 v11, v11, v117
    v_cvt_pk_bf16_f32 v56, v10, v11
    v_lshlrev_b32 v10, 16, v57
    v_and_b32 v11, 0xffff0000, v57
    v_mul_f32 v10, v10, v118
    v_mul_f32 v11, v11, v119
    v_cvt_pk_bf16_f32 v57, v10, v11
    v_lshlrev_b32 v10, 16, v58
    v_and_b32 v11, 0xffff0000, v58
    v_mul_f32 v10, v10, v120
    v_mul_f32 v11, v11, v121
    v_cvt_pk_bf16_f32 v58, v10, v11
    v_lshlrev_b32 v10, 16, v59
    v_and_b32 v11, 0xffff0000, v59
    v_mul_f32 v10, v10, v122
    v_mul_f32 v11, v11, v123
    v_cvt_pk_bf16_f32 v59, v10, v11
    global_store_dwordx4 v1, v[56:59], s[18:19]
    s_add_u32 s18, s18, 12288
    s_addc_u32 s19, s19, 0
    v_lshlrev_b32 v10, 16, v60
    v_and_b32 v11, 0xffff0000, v60
    v_mul_f32 v10, v10, v116
    v_mul_f32 v11, v11, v117
    v_cvt_pk_bf16_f32 v60, v10, v11
    v_lshlrev_b32 v10, 16, v61
    v_and_b32 v11, 0xffff0000, v61
    v_mul_f32 v10, v10, v118
    v_mul_f32 v11, v11, v119
    v_cvt_pk_bf16_f32 v61, v10, v11
    v_lshlrev_b32 v10, 16, v62
    v_and_b32 v11, 0xffff0000, v62
    v_mul_f32 v10, v10, v120
    v_mul_f32 v11, v11, v121
    v_cvt_pk_bf16_f32 v62, v10, v11
    v_lshlrev_b32 v10, 16, v63
    v_and_b32 v11, 0xffff0000, v63
    v_mul_f32 v10, v10, v122
    v_mul_f32 v11, v11, v123
    v_cvt_pk_bf16_f32 v63, v10, v11
    global_store_dwordx4 v1, v[60:63], s[18:19]
    s_add_u32 s18, s18, 12288
    s_addc_u32 s19, s19, 0
    v_lshlrev_b32 v10, 16, v64
    v_and_b32 v11, 0xffff0000, v64
    v_mul_f32 v10, v10, v116
    v_mul_f32 v11, v11, v117
    v_cvt_pk_bf16_f32 v64, v10, v11
    v_lshlrev_b32 v10, 16, v65
    v_and_b32 v11, 0xffff0000, v65
    v_mul_f32 v10, v10, v118
    v_mul_f32 v11, v11, v119
    v_cvt_pk_bf16_f32 v65, v10, v11
    v_lshlrev_b32 v10, 16, v66
    v_and_b32 v11, 0xffff0000, v66
    v_mul_f32 v10, v10, v120
    v_mul_f32 v11, v11, v121
    v_cvt_pk_bf16_f32 v66, v10, v11
    v_lshlrev_b32 v10, 16, v67
    v_and_b32 v11, 0xffff0000, v67
    v_mul_f32 v10, v10, v122
    v_mul_f32 v11, v11, v123
    v_cvt_pk_bf16_f32 v67, v10, v11
    global_store_dwordx4 v1, v[64:67], s[18:19]
    s_add_u32 s18, s18, 12288
    s_addc_u32 s19, s19, 0
    v_lshlrev_b32 v10, 16, v68
    v_and_b32 v11, 0xffff0000, v68
    v_mul_f32 v10, v10, v116
    v_mul_f32 v11, v11, v117
    v_cvt_pk_bf16_f32 v68, v10, v11
    v_lshlrev_b32 v10, 16, v69
    v_and_b32 v11, 0xffff0000, v69
    v_mul_f32 v10, v10, v118
    v_mul_f32 v11, v11, v119
    v_cvt_pk_bf16_f32 v69, v10, v11
    v_lshlrev_b32 v10, 16, v70
    v_and_b32 v11, 0xffff0000, v70
    v_mul_f32 v10, v10, v120
    v_mul_f32 v11, v11, v121
    v_cvt_pk_bf16_f32 v70, v10, v11
    v_lshlrev_b32 v10, 16, v71
    v_and_b32 v11, 0xffff0000, v71
    v_mul_f32 v10, v10, v122
    v_mul_f32 v11, v11, v123
    v_cvt_pk_bf16_f32 v71, v10, v11
    global_store_dwordx4 v1, v[68:71], s[18:19]
    s_add_u32 s18, s18, 12288
    s_addc_u32 s19, s19, 0
    v_lshlrev_b32 v10, 16, v72
    v_and_b32 v11, 0xffff0000, v72
    v_mul_f32 v10, v10, v116
    v_mul_f32 v11, v11, v117
    v_cvt_pk_bf16_f32 v72, v10, v11
    v_lshlrev_b32 v10, 16, v73
    v_and_b32 v11, 0xffff0000, v73
    v_mul_f32 v10, v10, v118
    v_mul_f32 v11, v11, v119
    v_cvt_pk_bf16_f32 v73, v10, v11
    v_lshlrev_b32 v10, 16, v74
    v_and_b32 v11, 0xffff0000, v74
    v_mul_f32 v10, v10, v120
    v_mul_f32 v11, v11, v121
    v_cvt_pk_bf16_f32 v74, v10, v11
    v_lshlrev_b32 v10, 16, v75
    v_and_b32 v11, 0xffff0000, v75
    v_mul_f32 v10, v10, v122
    v_mul_f32 v11, v11, v123
    v_cvt_pk_bf16_f32 v75, v10, v11
    global_store_dwordx4 v1, v[72:75], s[18:19]
    s_add_u32 s18, s18, 12288
    s_addc_u32 s19, s19, 0
    v_lshlrev_b32 v10, 16, v76
    v_and_b32 v11, 0xffff0000, v76
    v_mul_f32 v10, v10, v116
    v_mul_f32 v11, v11, v117
    v_cvt_pk_bf16_f32 v76, v10, v11
    v_lshlrev_b32 v10, 16, v77
    v_and_b32 v11, 0xffff0000, v77
    v_mul_f32 v10, v10, v118
    v_mul_f32 v11, v11, v119
    v_cvt_pk_bf16_f32 v77, v10, v11
    v_lshlrev_b32 v10, 16, v78
    v_and_b32 v11, 0xffff0000, v78
    v_mul_f32 v10, v10, v120
    v_mul_f32 v11, v11, v121
    v_cvt_pk_bf16_f32 v78, v10, v11
    v_lshlrev_b32 v10, 16, v79
    v_and_b32 v11, 0xffff0000, v79
    v_mul_f32 v10, v10, v122
    v_mul_f32 v11, v11, v123
    v_cvt_pk_bf16_f32 v79, v10, v11
    global_store_dwordx4 v1, v[76:79], s[18:19]
L_end:
    s_endpgm
.section .rodata,"a"
.p2align 6
.amdhsa_kernel standalone__channel_attn_se__vision_kernel
  .amdhsa_next_free_vgpr 128
  .amdhsa_next_free_sgpr 72
  .amdhsa_accum_offset 128
  .amdhsa_group_segment_fixed_size 0
  .amdhsa_kernarg_size 48
  .amdhsa_user_sgpr_count 2
  .amdhsa_user_sgpr_kernarg_segment_ptr 1
  .amdhsa_system_sgpr_workgroup_id_x 1
  .amdhsa_float_denorm_mode_32 3
.end_amdhsa_kernel
```

```asm
; @launch grid=(256,1,1) block=(768,1,1) lds=32768
.amdgcn_target "amdgcn-amd-amdhsa--gfx950"
.text
.globl standalone__channel_attn_se__vision_kernel
.p2align 8
.type standalone__channel_attn_se__vision_kernel,@function
standalone__channel_attn_se__vision_kernel:
    s_cmp_ge_u32 s2, 256
    s_cbranch_scc1 L_end
    s_load_dwordx4 s[4:7], s[0:1], 0
    s_load_dwordx4 s[8:11], s[0:1], 16
    s_load_dwordx4 s[12:15], s[0:1], 32
    v_lshrrev_b32 v10, 6, v0
    v_lshlrev_b32 v1, 4, v0
    v_readfirstlane_b32 s20, v10
    s_mul_i32 s3, s2, 196608
    s_and_b32 s22, s2, 7
    s_mul_i32 s22, s22, 1536
    s_mov_b32 s21, 0
    s_waitcnt lgkmcnt(0)
    s_add_u32 s16, s4, s3
    s_addc_u32 s17, s5, 0
    s_add_u32 s18, s10, s3
    s_addc_u32 s19, s11, 0
    s_add_u32 s24, s14, s22
    s_addc_u32 s25, s15, 0
    s_memtime s[64:65]
    s_cmp_lg_u32 s2, 0
    s_cbranch_scc1 L_nozero
    s_cmp_lg_u32 s20, 11
    s_cbranch_scc1 L_nozero
    v_mov_b32 v10, 0
    v_mov_b32 v11, 0
    v_mov_b32 v12, 0
    v_mov_b32 v13, 0
    v_and_b32 v14, 63, v0
    v_lshlrev_b32 v14, 4, v14
    global_store_dwordx4 v14, v[10:13], s[14:15] offset:0 sc1
    global_store_dwordx4 v14, v[10:13], s[14:15] offset:1024 sc1
    global_store_dwordx4 v14, v[10:13], s[14:15] offset:2048 sc1
    global_store_dwordx4 v14, v[10:13], s[14:15] offset:3072 sc1
    v_add_u32 v14, 4096, v14
    global_store_dwordx4 v14, v[10:13], s[14:15] offset:0 sc1
    global_store_dwordx4 v14, v[10:13], s[14:15] offset:1024 sc1
    global_store_dwordx4 v14, v[10:13], s[14:15] offset:2048 sc1
    global_store_dwordx4 v14, v[10:13], s[14:15] offset:3072 sc1
    v_add_u32 v14, 4096, v14
    global_store_dwordx4 v14, v[10:13], s[14:15] offset:0 sc1
    global_store_dwordx4 v14, v[10:13], s[14:15] offset:1024 sc1
    global_store_dwordx4 v14, v[10:13], s[14:15] offset:2048 sc1
    global_store_dwordx4 v14, v[10:13], s[14:15] offset:3072 sc1
    s_waitcnt vmcnt(0)
    v_mov_b32 v10, 1
    v_mov_b32 v14, 0
    global_store_dword v14, v10, s[12:13] sc1
L_nozero:
    global_load_dwordx4 v[16:19], v1, s[16:17]
    s_add_u32 s16, s16, 12288
    s_addc_u32 s17, s17, 0
    global_load_dwordx4 v[20:23], v1, s[16:17]
    s_add_u32 s16, s16, 12288
    s_addc_u32 s17, s17, 0
    global_load_dwordx4 v[24:27], v1, s[16:17]
    s_add_u32 s16, s16, 12288
    s_addc_u32 s17, s17, 0
    global_load_dwordx4 v[28:31], v1, s[16:17]
    s_add_u32 s16, s16, 12288
    s_addc_u32 s17, s17, 0
    global_load_dwordx4 v[32:35], v1, s[16:17]
    s_add_u32 s16, s16, 12288
    s_addc_u32 s17, s17, 0
    global_load_dwordx4 v[36:39], v1, s[16:17]
    s_add_u32 s16, s16, 12288
    s_addc_u32 s17, s17, 0
    global_load_dwordx4 v[40:43], v1, s[16:17]
    s_add_u32 s16, s16, 12288
    s_addc_u32 s17, s17, 0
    global_load_dwordx4 v[44:47], v1, s[16:17]
    s_add_u32 s16, s16, 12288
    s_addc_u32 s17, s17, 0
    global_load_dwordx4 v[48:51], v1, s[16:17]
    s_add_u32 s16, s16, 12288
    s_addc_u32 s17, s17, 0
    global_load_dwordx4 v[52:55], v1, s[16:17]
    s_add_u32 s16, s16, 12288
    s_addc_u32 s17, s17, 0
    global_load_dwordx4 v[56:59], v1, s[16:17]
    s_add_u32 s16, s16, 12288
    s_addc_u32 s17, s17, 0
    global_load_dwordx4 v[60:63], v1, s[16:17]
    s_add_u32 s16, s16, 12288
    s_addc_u32 s17, s17, 0
    global_load_dwordx4 v[64:67], v1, s[16:17]
    s_add_u32 s16, s16, 12288
    s_addc_u32 s17, s17, 0
    global_load_dwordx4 v[68:71], v1, s[16:17]
    s_add_u32 s16, s16, 12288
    s_addc_u32 s17, s17, 0
    global_load_dwordx4 v[72:75], v1, s[16:17]
    s_add_u32 s16, s16, 12288
    s_addc_u32 s17, s17, 0
    global_load_dwordx4 v[76:79], v1, s[16:17]
    v_mul_u32_u24 v10, 2731, v0
    v_lshrrev_b32 v10, 16, v10
    v_mul_u32_u24 v11, 24, v10
    v_sub_u32 v11, v0, v11
    v_mul_u32_u24 v124, 576, v10
    v_lshl_add_u32 v124, v11, 1, v124
    v_mul_u32_u24 v127, 48, v10
    v_lshlrev_b32 v126, 2, v11
    global_load_ushort v80, v124, s[6:7] offset:0
    global_load_ushort v81, v124, s[6:7] offset:48
    global_load_ushort v82, v124, s[6:7] offset:96
    global_load_ushort v83, v124, s[6:7] offset:144
    global_load_ushort v84, v124, s[6:7] offset:192
    global_load_ushort v85, v124, s[6:7] offset:240
    global_load_ushort v86, v124, s[6:7] offset:288
    global_load_ushort v87, v124, s[6:7] offset:336
    global_load_ushort v88, v124, s[6:7] offset:384
    global_load_ushort v89, v124, s[6:7] offset:432
    global_load_ushort v90, v124, s[6:7] offset:480
    global_load_ushort v91, v124, s[6:7] offset:528
    v_subrev_u32 v125, 384, v0
    v_cmp_gt_u32 vcc, 384, v0
    s_nop 1
    v_cndmask_b32 v125, v125, v0, vcc
    v_lshlrev_b32 v125, 1, v125
    global_load_ushort v92, v125, s[8:9] offset:0
    global_load_ushort v93, v125, s[8:9] offset:768
    global_load_ushort v94, v125, s[8:9] offset:1536
    global_load_ushort v95, v125, s[8:9] offset:2304
    global_load_ushort v96, v125, s[8:9] offset:3072
    v_add_u32 v125, 3840, v125
    global_load_ushort v97, v125, s[8:9] offset:0
    global_load_ushort v98, v125, s[8:9] offset:768
    global_load_ushort v99, v125, s[8:9] offset:1536
    global_load_ushort v100, v125, s[8:9] offset:2304
    global_load_ushort v101, v125, s[8:9] offset:3072
    v_add_u32 v125, 3840, v125
    global_load_ushort v102, v125, s[8:9] offset:0
    global_load_ushort v103, v125, s[8:9] offset:768
    global_load_ushort v104, v125, s[8:9] offset:1536
    global_load_ushort v105, v125, s[8:9] offset:2304
    global_load_ushort v106, v125, s[8:9] offset:3072
    v_add_u32 v125, 3840, v125
    global_load_ushort v107, v125, s[8:9] offset:0
    global_load_ushort v108, v125, s[8:9] offset:768
    global_load_ushort v109, v125, s[8:9] offset:1536
    global_load_ushort v110, v125, s[8:9] offset:2304
    global_load_ushort v111, v125, s[8:9] offset:3072
    v_add_u32 v125, 3840, v125
    global_load_ushort v112, v125, s[8:9] offset:0
    global_load_ushort v113, v125, s[8:9] offset:768
    global_load_ushort v114, v125, s[8:9] offset:1536
    global_load_ushort v115, v125, s[8:9] offset:2304
    v_and_b32 v10, 31, v0
    v_lshlrev_b32 v10, 2, v10
    v_mov_b32 v11, 0
    ds_write_b32 v10, v11 offset:26112
    v_mov_b32 v2, 0
    v_mov_b32 v3, 0
    v_mov_b32 v4, 0
    v_mov_b32 v5, 0
    v_mov_b32 v6, 0
    v_mov_b32 v7, 0
    v_mov_b32 v8, 0
    v_mov_b32 v9, 0
    s_waitcnt vmcnt(51)
    v_lshlrev_b32 v10, 16, v16
    v_and_b32 v11, 0xffff0000, v16
    v_add_f32 v2, v2, v10
    v_add_f32 v3, v3, v11
    v_lshlrev_b32 v10, 16, v17
    v_and_b32 v11, 0xffff0000, v17
    v_add_f32 v4, v4, v10
    v_add_f32 v5, v5, v11
    v_lshlrev_b32 v10, 16, v18
    v_and_b32 v11, 0xffff0000, v18
    v_add_f32 v6, v6, v10
    v_add_f32 v7, v7, v11
    v_lshlrev_b32 v10, 16, v19
    v_and_b32 v11, 0xffff0000, v19
    v_add_f32 v8, v8, v10
    v_add_f32 v9, v9, v11
    s_waitcnt vmcnt(50)
    v_lshlrev_b32 v10, 16, v20
    v_and_b32 v11, 0xffff0000, v20
    v_add_f32 v2, v2, v10
    v_add_f32 v3, v3, v11
    v_lshlrev_b32 v10, 16, v21
    v_and_b32 v11, 0xffff0000, v21
    v_add_f32 v4, v4, v10
    v_add_f32 v5, v5, v11
    v_lshlrev_b32 v10, 16, v22
    v_and_b32 v11, 0xffff0000, v22
    v_add_f32 v6, v6, v10
    v_add_f32 v7, v7, v11
    v_lshlrev_b32 v10, 16, v23
    v_and_b32 v11, 0xffff0000, v23
    v_add_f32 v8, v8, v10
    v_add_f32 v9, v9, v11
    s_waitcnt vmcnt(49)
    v_lshlrev_b32 v10, 16, v24
    v_and_b32 v11, 0xffff0000, v24
    v_add_f32 v2, v2, v10
    v_add_f32 v3, v3, v11
    v_lshlrev_b32 v10, 16, v25
    v_and_b32 v11, 0xffff0000, v25
    v_add_f32 v4, v4, v10
    v_add_f32 v5, v5, v11
    v_lshlrev_b32 v10, 16, v26
    v_and_b32 v11, 0xffff0000, v26
    v_add_f32 v6, v6, v10
    v_add_f32 v7, v7, v11
    v_lshlrev_b32 v10, 16, v27
    v_and_b32 v11, 0xffff0000, v27
    v_add_f32 v8, v8, v10
    v_add_f32 v9, v9, v11
    s_waitcnt vmcnt(48)
    v_lshlrev_b32 v10, 16, v28
    v_and_b32 v11, 0xffff0000, v28
    v_add_f32 v2, v2, v10
    v_add_f32 v3, v3, v11
    v_lshlrev_b32 v10, 16, v29
    v_and_b32 v11, 0xffff0000, v29
    v_add_f32 v4, v4, v10
    v_add_f32 v5, v5, v11
    v_lshlrev_b32 v10, 16, v30
    v_and_b32 v11, 0xffff0000, v30
    v_add_f32 v6, v6, v10
    v_add_f32 v7, v7, v11
    v_lshlrev_b32 v10, 16, v31
    v_and_b32 v11, 0xffff0000, v31
    v_add_f32 v8, v8, v10
    v_add_f32 v9, v9, v11
    s_waitcnt vmcnt(47)
    v_lshlrev_b32 v10, 16, v32
    v_and_b32 v11, 0xffff0000, v32
    v_add_f32 v2, v2, v10
    v_add_f32 v3, v3, v11
    v_lshlrev_b32 v10, 16, v33
    v_and_b32 v11, 0xffff0000, v33
    v_add_f32 v4, v4, v10
    v_add_f32 v5, v5, v11
    v_lshlrev_b32 v10, 16, v34
    v_and_b32 v11, 0xffff0000, v34
    v_add_f32 v6, v6, v10
    v_add_f32 v7, v7, v11
    v_lshlrev_b32 v10, 16, v35
    v_and_b32 v11, 0xffff0000, v35
    v_add_f32 v8, v8, v10
    v_add_f32 v9, v9, v11
    s_waitcnt vmcnt(46)
    v_lshlrev_b32 v10, 16, v36
    v_and_b32 v11, 0xffff0000, v36
    v_add_f32 v2, v2, v10
    v_add_f32 v3, v3, v11
    v_lshlrev_b32 v10, 16, v37
    v_and_b32 v11, 0xffff0000, v37
    v_add_f32 v4, v4, v10
    v_add_f32 v5, v5, v11
    v_lshlrev_b32 v10, 16, v38
    v_and_b32 v11, 0xffff0000, v38
    v_add_f32 v6, v6, v10
    v_add_f32 v7, v7, v11
    v_lshlrev_b32 v10, 16, v39
    v_and_b32 v11, 0xffff0000, v39
    v_add_f32 v8, v8, v10
    v_add_f32 v9, v9, v11
    s_waitcnt vmcnt(45)
    v_lshlrev_b32 v10, 16, v40
    v_and_b32 v11, 0xffff0000, v40
    v_add_f32 v2, v2, v10
    v_add_f32 v3, v3, v11
    v_lshlrev_b32 v10, 16, v41
    v_and_b32 v11, 0xffff0000, v41
    v_add_f32 v4, v4, v10
    v_add_f32 v5, v5, v11
    v_lshlrev_b32 v10, 16, v42
    v_and_b32 v11, 0xffff0000, v42
    v_add_f32 v6, v6, v10
    v_add_f32 v7, v7, v11
    v_lshlrev_b32 v10, 16, v43
    v_and_b32 v11, 0xffff0000, v43
    v_add_f32 v8, v8, v10
    v_add_f32 v9, v9, v11
    s_waitcnt vmcnt(44)
    v_lshlrev_b32 v10, 16, v44
    v_and_b32 v11, 0xffff0000, v44
    v_add_f32 v2, v2, v10
    v_add_f32 v3, v3, v11
    v_lshlrev_b32 v10, 16, v45
    v_and_b32 v11, 0xffff0000, v45
    v_add_f32 v4, v4, v10
    v_add_f32 v5, v5, v11
    v_lshlrev_b32 v10, 16, v46
    v_and_b32 v11, 0xffff0000, v46
    v_add_f32 v6, v6, v10
    v_add_f32 v7, v7, v11
    v_lshlrev_b32 v10, 16, v47
    v_and_b32 v11, 0xffff0000, v47
    v_add_f32 v8, v8, v10
    v_add_f32 v9, v9, v11
    s_waitcnt vmcnt(43)
    v_lshlrev_b32 v10, 16, v48
    v_and_b32 v11, 0xffff0000, v48
    v_add_f32 v2, v2, v10
    v_add_f32 v3, v3, v11
    v_lshlrev_b32 v10, 16, v49
    v_and_b32 v11, 0xffff0000, v49
    v_add_f32 v4, v4, v10
    v_add_f32 v5, v5, v11
    v_lshlrev_b32 v10, 16, v50
    v_and_b32 v11, 0xffff0000, v50
    v_add_f32 v6, v6, v10
    v_add_f32 v7, v7, v11
    v_lshlrev_b32 v10, 16, v51
    v_and_b32 v11, 0xffff0000, v51
    v_add_f32 v8, v8, v10
    v_add_f32 v9, v9, v11
    s_waitcnt vmcnt(42)
    v_lshlrev_b32 v10, 16, v52
    v_and_b32 v11, 0xffff0000, v52
    v_add_f32 v2, v2, v10
    v_add_f32 v3, v3, v11
    v_lshlrev_b32 v10, 16, v53
    v_and_b32 v11, 0xffff0000, v53
    v_add_f32 v4, v4, v10
    v_add_f32 v5, v5, v11
    v_lshlrev_b32 v10, 16, v54
    v_and_b32 v11, 0xffff0000, v54
    v_add_f32 v6, v6, v10
    v_add_f32 v7, v7, v11
    v_lshlrev_b32 v10, 16, v55
    v_and_b32 v11, 0xffff0000, v55
    v_add_f32 v8, v8, v10
    v_add_f32 v9, v9, v11
    s_waitcnt vmcnt(41)
    v_lshlrev_b32 v10, 16, v56
    v_and_b32 v11, 0xffff0000, v56
    v_add_f32 v2, v2, v10
    v_add_f32 v3, v3, v11
    v_lshlrev_b32 v10, 16, v57
    v_and_b32 v11, 0xffff0000, v57
    v_add_f32 v4, v4, v10
    v_add_f32 v5, v5, v11
    v_lshlrev_b32 v10, 16, v58
    v_and_b32 v11, 0xffff0000, v58
    v_add_f32 v6, v6, v10
    v_add_f32 v7, v7, v11
    v_lshlrev_b32 v10, 16, v59
    v_and_b32 v11, 0xffff0000, v59
    v_add_f32 v8, v8, v10
    v_add_f32 v9, v9, v11
    s_waitcnt vmcnt(40)
    v_lshlrev_b32 v10, 16, v60
    v_and_b32 v11, 0xffff0000, v60
    v_add_f32 v2, v2, v10
    v_add_f32 v3, v3, v11
    v_lshlrev_b32 v10, 16, v61
    v_and_b32 v11, 0xffff0000, v61
    v_add_f32 v4, v4, v10
    v_add_f32 v5, v5, v11
    v_lshlrev_b32 v10, 16, v62
    v_and_b32 v11, 0xffff0000, v62
    v_add_f32 v6, v6, v10
    v_add_f32 v7, v7, v11
    v_lshlrev_b32 v10, 16, v63
    v_and_b32 v11, 0xffff0000, v63
    v_add_f32 v8, v8, v10
    v_add_f32 v9, v9, v11
    s_waitcnt vmcnt(39)
    v_lshlrev_b32 v10, 16, v64
    v_and_b32 v11, 0xffff0000, v64
    v_add_f32 v2, v2, v10
    v_add_f32 v3, v3, v11
    v_lshlrev_b32 v10, 16, v65
    v_and_b32 v11, 0xffff0000, v65
    v_add_f32 v4, v4, v10
    v_add_f32 v5, v5, v11
    v_lshlrev_b32 v10, 16, v66
    v_and_b32 v11, 0xffff0000, v66
    v_add_f32 v6, v6, v10
    v_add_f32 v7, v7, v11
    v_lshlrev_b32 v10, 16, v67
    v_and_b32 v11, 0xffff0000, v67
    v_add_f32 v8, v8, v10
    v_add_f32 v9, v9, v11
    s_waitcnt vmcnt(38)
    v_lshlrev_b32 v10, 16, v68
    v_and_b32 v11, 0xffff0000, v68
    v_add_f32 v2, v2, v10
    v_add_f32 v3, v3, v11
    v_lshlrev_b32 v10, 16, v69
    v_and_b32 v11, 0xffff0000, v69
    v_add_f32 v4, v4, v10
    v_add_f32 v5, v5, v11
    v_lshlrev_b32 v10, 16, v70
    v_and_b32 v11, 0xffff0000, v70
    v_add_f32 v6, v6, v10
    v_add_f32 v7, v7, v11
    v_lshlrev_b32 v10, 16, v71
    v_and_b32 v11, 0xffff0000, v71
    v_add_f32 v8, v8, v10
    v_add_f32 v9, v9, v11
    s_waitcnt vmcnt(37)
    v_lshlrev_b32 v10, 16, v72
    v_and_b32 v11, 0xffff0000, v72
    v_add_f32 v2, v2, v10
    v_add_f32 v3, v3, v11
    v_lshlrev_b32 v10, 16, v73
    v_and_b32 v11, 0xffff0000, v73
    v_add_f32 v4, v4, v10
    v_add_f32 v5, v5, v11
    v_lshlrev_b32 v10, 16, v74
    v_and_b32 v11, 0xffff0000, v74
    v_add_f32 v6, v6, v10
    v_add_f32 v7, v7, v11
    v_lshlrev_b32 v10, 16, v75
    v_and_b32 v11, 0xffff0000, v75
    v_add_f32 v8, v8, v10
    v_add_f32 v9, v9, v11
    s_waitcnt vmcnt(36)
    v_lshlrev_b32 v10, 16, v76
    v_and_b32 v11, 0xffff0000, v76
    v_add_f32 v2, v2, v10
    v_add_f32 v3, v3, v11
    v_lshlrev_b32 v10, 16, v77
    v_and_b32 v11, 0xffff0000, v77
    v_add_f32 v4, v4, v10
    v_add_f32 v5, v5, v11
    v_lshlrev_b32 v10, 16, v78
    v_and_b32 v11, 0xffff0000, v78
    v_add_f32 v6, v6, v10
    v_add_f32 v7, v7, v11
    v_lshlrev_b32 v10, 16, v79
    v_and_b32 v11, 0xffff0000, v79
    v_add_f32 v8, v8, v10
    v_add_f32 v9, v9, v11
    v_lshlrev_b32 v10, 5, v0
    ds_write_b128 v10, v[2:5] offset:0
    ds_write_b128 v10, v[6:9] offset:16
    s_cmp_lg_u32 s20, 0
    s_cbranch_scc1 L_flag_ok
    v_mov_b32 v14, 0
L_flag:
    global_load_dword v10, v14, s[12:13] sc1
    s_waitcnt vmcnt(0)
    v_readfirstlane_b32 s22, v10
    s_cmp_lg_u32 s22, 0
    s_cbranch_scc1 L_flag_ok
    s_sleep 1
    s_add_u32 s21, s21, 1
    s_cmp_lt_u32 s21, 200000
    s_cbranch_scc1 L_flag
L_flag_ok:
    s_waitcnt lgkmcnt(0)
    s_memtime s[66:67]
    s_barrier
    s_cmp_ge_u32 s20, 6
    s_cbranch_scc1 L_skip_atomic
    v_lshlrev_b32 v14, 2, v0
    ds_read_b32 v116, v14 offset:0
    ds_read_b32 v117, v14 offset:1536
    ds_read_b32 v118, v14 offset:3072
    ds_read_b32 v119, v14 offset:4608
    ds_read_b32 v120, v14 offset:6144
    ds_read_b32 v121, v14 offset:7680
    ds_read_b32 v122, v14 offset:9216
    ds_read_b32 v123, v14 offset:10752
    ds_read_b32 v10, v14 offset:12288
    ds_read_b32 v11, v14 offset:13824
    ds_read_b32 v12, v14 offset:15360
    ds_read_b32 v13, v14 offset:16896
    ds_read_b32 v2, v14 offset:18432
    ds_read_b32 v3, v14 offset:19968
    ds_read_b32 v4, v14 offset:21504
    ds_read_b32 v5, v14 offset:23040
    s_waitcnt lgkmcnt(0)
    v_add_f32 v116, v116, v117
    v_add_f32 v118, v118, v119
    v_add_f32 v120, v120, v121
    v_add_f32 v122, v122, v123
    v_add_f32 v10, v10, v11
    v_add_f32 v12, v12, v13
    v_add_f32 v2, v2, v3
    v_add_f32 v4, v4, v5
    v_add_f32 v116, v116, v118
    v_add_f32 v120, v120, v122
    v_add_f32 v10, v10, v12
    v_add_f32 v2, v2, v4
    v_add_f32 v116, v116, v120
    v_add_f32 v10, v10, v2
    v_add_f32 v116, v116, v10
    global_atomic_add_f32 v14, v116, s[24:25]
    s_waitcnt vmcnt(0)
L_skip_atomic:
    s_barrier
    s_memtime s[68:69]
    s_cmp_lg_u32 s20, 0
    s_cbranch_scc1 L_arrived
    v_mov_b32 v14, 0
    v_mov_b32 v10, 1
    s_mov_b64 s[28:29], exec
    s_mov_b64 exec, 1
    global_atomic_add v14, v10, s[12:13] offset:128
    s_mov_b64 exec, s[28:29]
L_poll:
    global_load_dword v10, v14, s[12:13] offset:128 sc1
    s_waitcnt vmcnt(0)
    v_readfirstlane_b32 s22, v10
    s_cmp_ge_u32 s22, 256
    s_cbranch_scc1 L_arrived
    s_sleep 1
    s_add_u32 s21, s21, 1
    s_cmp_lt_u32 s21, 200000
    s_cbranch_scc1 L_poll
L_arrived:
    s_barrier
    s_memtime s[70:71]
    s_cmp_ge_u32 s20, 6
    s_cbranch_scc1 L_skip_mean
    v_lshlrev_b32 v14, 2, v0
    global_load_dword v116, v14, s[14:15] offset:0 sc1
    global_load_dword v117, v14, s[14:15] offset:1536 sc1
    v_add_u32 v14, 3072, v14
    global_load_dword v118, v14, s[14:15] offset:0 sc1
    global_load_dword v119, v14, s[14:15] offset:1536 sc1
    v_add_u32 v14, 3072, v14
    global_load_dword v120, v14, s[14:15] offset:0 sc1
    global_load_dword v121, v14, s[14:15] offset:1536 sc1
    v_add_u32 v14, 3072, v14
    global_load_dword v122, v14, s[14:15] offset:0 sc1
    global_load_dword v123, v14, s[14:15] offset:1536 sc1
    s_waitcnt vmcnt(0)
    v_add_f32 v116, v116, v117
    v_add_f32 v118, v118, v119
    v_add_f32 v120, v120, v121
    v_add_f32 v122, v122, v123
    v_add_f32 v116, v116, v118
    v_add_f32 v120, v120, v122
    v_add_f32 v116, v116, v120
    v_mul_f32 v10, 0x37800000, v116
    v_cvt_pk_bf16_f32 v10, v10, v10
    v_lshlrev_b32 v10, 16, v10
    v_lshlrev_b32 v14, 2, v0
    ds_write_b32 v14, v10 offset:24576
    s_waitcnt lgkmcnt(0)
L_skip_mean:
    s_barrier
    ds_read_b128 v[116:119], v127 offset:24576
    ds_read_b128 v[120:123], v127 offset:24592
    ds_read_b128 v[10:13], v127 offset:24608
    v_lshlrev_b32 v80, 16, v80
    v_lshlrev_b32 v81, 16, v81
    v_lshlrev_b32 v82, 16, v82
    v_lshlrev_b32 v83, 16, v83
    v_lshlrev_b32 v84, 16, v84
    v_lshlrev_b32 v85, 16, v85
    v_lshlrev_b32 v86, 16, v86
    v_lshlrev_b32 v87, 16, v87
    v_lshlrev_b32 v88, 16, v88
    v_lshlrev_b32 v89, 16, v89
    v_lshlrev_b32 v90, 16, v90
    v_lshlrev_b32 v91, 16, v91
    v_lshlrev_b32 v92, 16, v92
    v_lshlrev_b32 v93, 16, v93
    v_lshlrev_b32 v94, 16, v94
    v_lshlrev_b32 v95, 16, v95
    v_lshlrev_b32 v96, 16, v96
    v_lshlrev_b32 v97, 16, v97
    v_lshlrev_b32 v98, 16, v98
    v_lshlrev_b32 v99, 16, v99
    v_lshlrev_b32 v100, 16, v100
    v_lshlrev_b32 v101, 16, v101
    v_lshlrev_b32 v102, 16, v102
    v_lshlrev_b32 v103, 16, v103
    v_lshlrev_b32 v104, 16, v104
    v_lshlrev_b32 v105, 16, v105
    v_lshlrev_b32 v106, 16, v106
    v_lshlrev_b32 v107, 16, v107
    v_lshlrev_b32 v108, 16, v108
    v_lshlrev_b32 v109, 16, v109
    v_lshlrev_b32 v110, 16, v110
    v_lshlrev_b32 v111, 16, v111
    v_lshlrev_b32 v112, 16, v112
    v_lshlrev_b32 v113, 16, v113
    v_lshlrev_b32 v114, 16, v114
    v_lshlrev_b32 v115, 16, v115
    s_waitcnt lgkmcnt(0)
    v_mul_f32 v14, v116, v80
    v_fmac_f32 v14, v117, v81
    v_fmac_f32 v14, v118, v82
    v_fmac_f32 v14, v119, v83
    v_fmac_f32 v14, v120, v84
    v_fmac_f32 v14, v121, v85
    v_fmac_f32 v14, v122, v86
    v_fmac_f32 v14, v123, v87
    v_fmac_f32 v14, v10, v88
    v_fmac_f32 v14, v11, v89
    v_fmac_f32 v14, v12, v90
    v_fmac_f32 v14, v13, v91
    ds_add_f32 v126, v14 offset:26112
    s_waitcnt lgkmcnt(0)
    s_barrier
    v_and_b32 v10, 31, v0
    v_lshlrev_b32 v10, 2, v10
    ds_read_b32 v10, v10 offset:26112
    s_waitcnt lgkmcnt(0)
    v_cvt_pk_bf16_f32 v10, v10, v10
    v_lshlrev_b32 v10, 16, v10
    v_mul_f32 v11, 0xbfb8aa3b, v10
    v_exp_f32 v11, v11
    s_nop 0
    v_add_f32 v11, 1.0, v11
    v_rcp_f32 v11, v11
    s_nop 0
    v_mul_f32 v10, v10, v11
    v_cvt_pk_bf16_f32 v10, v10, v10
    v_lshlrev_b32 v10, 16, v10
    s_nop 0
    v_readlane_b32 s40, v10, 0
    v_readlane_b32 s41, v10, 1
    v_readlane_b32 s42, v10, 2
    v_readlane_b32 s43, v10, 3
    v_readlane_b32 s44, v10, 4
    v_readlane_b32 s45, v10, 5
    v_readlane_b32 s46, v10, 6
    v_readlane_b32 s47, v10, 7
    v_readlane_b32 s48, v10, 8
    v_readlane_b32 s49, v10, 9
    v_readlane_b32 s50, v10, 10
    v_readlane_b32 s51, v10, 11
    v_readlane_b32 s52, v10, 12
    v_readlane_b32 s53, v10, 13
    v_readlane_b32 s54, v10, 14
    v_readlane_b32 s55, v10, 15
    v_readlane_b32 s56, v10, 16
    v_readlane_b32 s57, v10, 17
    v_readlane_b32 s58, v10, 18
    v_readlane_b32 s59, v10, 19
    v_readlane_b32 s60, v10, 20
    v_readlane_b32 s61, v10, 21
    v_readlane_b32 s62, v10, 22
    v_readlane_b32 s63, v10, 23
    s_nop 1
    v_mul_f32 v14, s40, v92
    v_fmac_f32 v14, s41, v93
    v_fmac_f32 v14, s42, v94
    v_fmac_f32 v14, s43, v95
    v_fmac_f32 v14, s44, v96
    v_fmac_f32 v14, s45, v97
    v_fmac_f32 v14, s46, v98
    v_fmac_f32 v14, s47, v99
    v_fmac_f32 v14, s48, v100
    v_fmac_f32 v14, s49, v101
    v_fmac_f32 v14, s50, v102
    v_fmac_f32 v14, s51, v103
    v_fmac_f32 v14, s52, v104
    v_fmac_f32 v14, s53, v105
    v_fmac_f32 v14, s54, v106
    v_fmac_f32 v14, s55, v107
    v_fmac_f32 v14, s56, v108
    v_fmac_f32 v14, s57, v109
    v_fmac_f32 v14, s58, v110
    v_fmac_f32 v14, s59, v111
    v_fmac_f32 v14, s60, v112
    v_fmac_f32 v14, s61, v113
    v_fmac_f32 v14, s62, v114
    v_fmac_f32 v14, s63, v115
    v_cvt_pk_bf16_f32 v14, v14, v14
    v_lshlrev_b32 v14, 16, v14
    v_mul_f32 v11, 0xbfb8aa3b, v14
    v_exp_f32 v11, v11
    s_nop 0
    v_add_f32 v11, 1.0, v11
    v_rcp_f32 v11, v11
    s_nop 0
    v_cvt_pk_bf16_f32 v11, v11, v11
    v_lshlrev_b32 v11, 16, v11
    v_subrev_u32 v10, 384, v0
    v_cmp_gt_u32 vcc, 384, v0
    s_nop 1
    v_cndmask_b32 v10, v10, v0, vcc
    v_lshlrev_b32 v10, 2, v10
    ds_write_b32 v10, v11 offset:26240
    s_waitcnt lgkmcnt(0)
    s_barrier
    s_memtime s[72:73]
    v_mul_u32_u24 v10, 1366, v0
    v_lshrrev_b32 v10, 16, v10
    v_mul_u32_u24 v10, 48, v10
    v_sub_u32 v10, v0, v10
    v_lshlrev_b32 v10, 5, v10
    ds_read_b128 v[116:119], v10 offset:26240
    ds_read_b128 v[120:123], v10 offset:26256
    s_waitcnt lgkmcnt(0)
    v_lshlrev_b32 v10, 16, v16
    v_and_b32 v11, 0xffff0000, v16
    v_mul_f32 v10, v10, v116
    v_mul_f32 v11, v11, v117
    v_cvt_pk_bf16_f32 v16, v10, v11
    v_lshlrev_b32 v10, 16, v17
    v_and_b32 v11, 0xffff0000, v17
    v_mul_f32 v10, v10, v118
    v_mul_f32 v11, v11, v119
    v_cvt_pk_bf16_f32 v17, v10, v11
    v_lshlrev_b32 v10, 16, v18
    v_and_b32 v11, 0xffff0000, v18
    v_mul_f32 v10, v10, v120
    v_mul_f32 v11, v11, v121
    v_cvt_pk_bf16_f32 v18, v10, v11
    v_lshlrev_b32 v10, 16, v19
    v_and_b32 v11, 0xffff0000, v19
    v_mul_f32 v10, v10, v122
    v_mul_f32 v11, v11, v123
    v_cvt_pk_bf16_f32 v19, v10, v11
    global_store_dwordx4 v1, v[16:19], s[18:19]
    s_add_u32 s18, s18, 12288
    s_addc_u32 s19, s19, 0
    v_lshlrev_b32 v10, 16, v20
    v_and_b32 v11, 0xffff0000, v20
    v_mul_f32 v10, v10, v116
    v_mul_f32 v11, v11, v117
    v_cvt_pk_bf16_f32 v20, v10, v11
    v_lshlrev_b32 v10, 16, v21
    v_and_b32 v11, 0xffff0000, v21
    v_mul_f32 v10, v10, v118
    v_mul_f32 v11, v11, v119
    v_cvt_pk_bf16_f32 v21, v10, v11
    v_lshlrev_b32 v10, 16, v22
    v_and_b32 v11, 0xffff0000, v22
    v_mul_f32 v10, v10, v120
    v_mul_f32 v11, v11, v121
    v_cvt_pk_bf16_f32 v22, v10, v11
    v_lshlrev_b32 v10, 16, v23
    v_and_b32 v11, 0xffff0000, v23
    v_mul_f32 v10, v10, v122
    v_mul_f32 v11, v11, v123
    v_cvt_pk_bf16_f32 v23, v10, v11
    global_store_dwordx4 v1, v[20:23], s[18:19]
    s_add_u32 s18, s18, 12288
    s_addc_u32 s19, s19, 0
    v_lshlrev_b32 v10, 16, v24
    v_and_b32 v11, 0xffff0000, v24
    v_mul_f32 v10, v10, v116
    v_mul_f32 v11, v11, v117
    v_cvt_pk_bf16_f32 v24, v10, v11
    v_lshlrev_b32 v10, 16, v25
    v_and_b32 v11, 0xffff0000, v25
    v_mul_f32 v10, v10, v118
    v_mul_f32 v11, v11, v119
    v_cvt_pk_bf16_f32 v25, v10, v11
    v_lshlrev_b32 v10, 16, v26
    v_and_b32 v11, 0xffff0000, v26
    v_mul_f32 v10, v10, v120
    v_mul_f32 v11, v11, v121
    v_cvt_pk_bf16_f32 v26, v10, v11
    v_lshlrev_b32 v10, 16, v27
    v_and_b32 v11, 0xffff0000, v27
    v_mul_f32 v10, v10, v122
    v_mul_f32 v11, v11, v123
    v_cvt_pk_bf16_f32 v27, v10, v11
    global_store_dwordx4 v1, v[24:27], s[18:19]
    s_add_u32 s18, s18, 12288
    s_addc_u32 s19, s19, 0
    v_lshlrev_b32 v10, 16, v28
    v_and_b32 v11, 0xffff0000, v28
    v_mul_f32 v10, v10, v116
    v_mul_f32 v11, v11, v117
    v_cvt_pk_bf16_f32 v28, v10, v11
    v_lshlrev_b32 v10, 16, v29
    v_and_b32 v11, 0xffff0000, v29
    v_mul_f32 v10, v10, v118
    v_mul_f32 v11, v11, v119
    v_cvt_pk_bf16_f32 v29, v10, v11
    v_lshlrev_b32 v10, 16, v30
    v_and_b32 v11, 0xffff0000, v30
    v_mul_f32 v10, v10, v120
    v_mul_f32 v11, v11, v121
    v_cvt_pk_bf16_f32 v30, v10, v11
    v_lshlrev_b32 v10, 16, v31
    v_and_b32 v11, 0xffff0000, v31
    v_mul_f32 v10, v10, v122
    v_mul_f32 v11, v11, v123
    v_cvt_pk_bf16_f32 v31, v10, v11
    global_store_dwordx4 v1, v[28:31], s[18:19]
    s_add_u32 s18, s18, 12288
    s_addc_u32 s19, s19, 0
    v_lshlrev_b32 v10, 16, v32
    v_and_b32 v11, 0xffff0000, v32
    v_mul_f32 v10, v10, v116
    v_mul_f32 v11, v11, v117
    v_cvt_pk_bf16_f32 v32, v10, v11
    v_lshlrev_b32 v10, 16, v33
    v_and_b32 v11, 0xffff0000, v33
    v_mul_f32 v10, v10, v118
    v_mul_f32 v11, v11, v119
    v_cvt_pk_bf16_f32 v33, v10, v11
    v_lshlrev_b32 v10, 16, v34
    v_and_b32 v11, 0xffff0000, v34
    v_mul_f32 v10, v10, v120
    v_mul_f32 v11, v11, v121
    v_cvt_pk_bf16_f32 v34, v10, v11
    v_lshlrev_b32 v10, 16, v35
    v_and_b32 v11, 0xffff0000, v35
    v_mul_f32 v10, v10, v122
    v_mul_f32 v11, v11, v123
    v_cvt_pk_bf16_f32 v35, v10, v11
    global_store_dwordx4 v1, v[32:35], s[18:19]
    s_add_u32 s18, s18, 12288
    s_addc_u32 s19, s19, 0
    v_lshlrev_b32 v10, 16, v36
    v_and_b32 v11, 0xffff0000, v36
    v_mul_f32 v10, v10, v116
    v_mul_f32 v11, v11, v117
    v_cvt_pk_bf16_f32 v36, v10, v11
    v_lshlrev_b32 v10, 16, v37
    v_and_b32 v11, 0xffff0000, v37
    v_mul_f32 v10, v10, v118
    v_mul_f32 v11, v11, v119
    v_cvt_pk_bf16_f32 v37, v10, v11
    v_lshlrev_b32 v10, 16, v38
    v_and_b32 v11, 0xffff0000, v38
    v_mul_f32 v10, v10, v120
    v_mul_f32 v11, v11, v121
    v_cvt_pk_bf16_f32 v38, v10, v11
    v_lshlrev_b32 v10, 16, v39
    v_and_b32 v11, 0xffff0000, v39
    v_mul_f32 v10, v10, v122
    v_mul_f32 v11, v11, v123
    v_cvt_pk_bf16_f32 v39, v10, v11
    global_store_dwordx4 v1, v[36:39], s[18:19]
    s_add_u32 s18, s18, 12288
    s_addc_u32 s19, s19, 0
    v_lshlrev_b32 v10, 16, v40
    v_and_b32 v11, 0xffff0000, v40
    v_mul_f32 v10, v10, v116
    v_mul_f32 v11, v11, v117
    v_cvt_pk_bf16_f32 v40, v10, v11
    v_lshlrev_b32 v10, 16, v41
    v_and_b32 v11, 0xffff0000, v41
    v_mul_f32 v10, v10, v118
    v_mul_f32 v11, v11, v119
    v_cvt_pk_bf16_f32 v41, v10, v11
    v_lshlrev_b32 v10, 16, v42
    v_and_b32 v11, 0xffff0000, v42
    v_mul_f32 v10, v10, v120
    v_mul_f32 v11, v11, v121
    v_cvt_pk_bf16_f32 v42, v10, v11
    v_lshlrev_b32 v10, 16, v43
    v_and_b32 v11, 0xffff0000, v43
    v_mul_f32 v10, v10, v122
    v_mul_f32 v11, v11, v123
    v_cvt_pk_bf16_f32 v43, v10, v11
    global_store_dwordx4 v1, v[40:43], s[18:19]
    s_add_u32 s18, s18, 12288
    s_addc_u32 s19, s19, 0
    v_lshlrev_b32 v10, 16, v44
    v_and_b32 v11, 0xffff0000, v44
    v_mul_f32 v10, v10, v116
    v_mul_f32 v11, v11, v117
    v_cvt_pk_bf16_f32 v44, v10, v11
    v_lshlrev_b32 v10, 16, v45
    v_and_b32 v11, 0xffff0000, v45
    v_mul_f32 v10, v10, v118
    v_mul_f32 v11, v11, v119
    v_cvt_pk_bf16_f32 v45, v10, v11
    v_lshlrev_b32 v10, 16, v46
    v_and_b32 v11, 0xffff0000, v46
    v_mul_f32 v10, v10, v120
    v_mul_f32 v11, v11, v121
    v_cvt_pk_bf16_f32 v46, v10, v11
    v_lshlrev_b32 v10, 16, v47
    v_and_b32 v11, 0xffff0000, v47
    v_mul_f32 v10, v10, v122
    v_mul_f32 v11, v11, v123
    v_cvt_pk_bf16_f32 v47, v10, v11
    global_store_dwordx4 v1, v[44:47], s[18:19]
    s_add_u32 s18, s18, 12288
    s_addc_u32 s19, s19, 0
    v_lshlrev_b32 v10, 16, v48
    v_and_b32 v11, 0xffff0000, v48
    v_mul_f32 v10, v10, v116
    v_mul_f32 v11, v11, v117
    v_cvt_pk_bf16_f32 v48, v10, v11
    v_lshlrev_b32 v10, 16, v49
    v_and_b32 v11, 0xffff0000, v49
    v_mul_f32 v10, v10, v118
    v_mul_f32 v11, v11, v119
    v_cvt_pk_bf16_f32 v49, v10, v11
    v_lshlrev_b32 v10, 16, v50
    v_and_b32 v11, 0xffff0000, v50
    v_mul_f32 v10, v10, v120
    v_mul_f32 v11, v11, v121
    v_cvt_pk_bf16_f32 v50, v10, v11
    v_lshlrev_b32 v10, 16, v51
    v_and_b32 v11, 0xffff0000, v51
    v_mul_f32 v10, v10, v122
    v_mul_f32 v11, v11, v123
    v_cvt_pk_bf16_f32 v51, v10, v11
    global_store_dwordx4 v1, v[48:51], s[18:19]
    s_add_u32 s18, s18, 12288
    s_addc_u32 s19, s19, 0
    v_lshlrev_b32 v10, 16, v52
    v_and_b32 v11, 0xffff0000, v52
    v_mul_f32 v10, v10, v116
    v_mul_f32 v11, v11, v117
    v_cvt_pk_bf16_f32 v52, v10, v11
    v_lshlrev_b32 v10, 16, v53
    v_and_b32 v11, 0xffff0000, v53
    v_mul_f32 v10, v10, v118
    v_mul_f32 v11, v11, v119
    v_cvt_pk_bf16_f32 v53, v10, v11
    v_lshlrev_b32 v10, 16, v54
    v_and_b32 v11, 0xffff0000, v54
    v_mul_f32 v10, v10, v120
    v_mul_f32 v11, v11, v121
    v_cvt_pk_bf16_f32 v54, v10, v11
    v_lshlrev_b32 v10, 16, v55
    v_and_b32 v11, 0xffff0000, v55
    v_mul_f32 v10, v10, v122
    v_mul_f32 v11, v11, v123
    v_cvt_pk_bf16_f32 v55, v10, v11
    global_store_dwordx4 v1, v[52:55], s[18:19]
    s_add_u32 s18, s18, 12288
    s_addc_u32 s19, s19, 0
    v_lshlrev_b32 v10, 16, v56
    v_and_b32 v11, 0xffff0000, v56
    v_mul_f32 v10, v10, v116
    v_mul_f32 v11, v11, v117
    v_cvt_pk_bf16_f32 v56, v10, v11
    v_lshlrev_b32 v10, 16, v57
    v_and_b32 v11, 0xffff0000, v57
    v_mul_f32 v10, v10, v118
    v_mul_f32 v11, v11, v119
    v_cvt_pk_bf16_f32 v57, v10, v11
    v_lshlrev_b32 v10, 16, v58
    v_and_b32 v11, 0xffff0000, v58
    v_mul_f32 v10, v10, v120
    v_mul_f32 v11, v11, v121
    v_cvt_pk_bf16_f32 v58, v10, v11
    v_lshlrev_b32 v10, 16, v59
    v_and_b32 v11, 0xffff0000, v59
    v_mul_f32 v10, v10, v122
    v_mul_f32 v11, v11, v123
    v_cvt_pk_bf16_f32 v59, v10, v11
    global_store_dwordx4 v1, v[56:59], s[18:19]
    s_add_u32 s18, s18, 12288
    s_addc_u32 s19, s19, 0
    v_lshlrev_b32 v10, 16, v60
    v_and_b32 v11, 0xffff0000, v60
    v_mul_f32 v10, v10, v116
    v_mul_f32 v11, v11, v117
    v_cvt_pk_bf16_f32 v60, v10, v11
    v_lshlrev_b32 v10, 16, v61
    v_and_b32 v11, 0xffff0000, v61
    v_mul_f32 v10, v10, v118
    v_mul_f32 v11, v11, v119
    v_cvt_pk_bf16_f32 v61, v10, v11
    v_lshlrev_b32 v10, 16, v62
    v_and_b32 v11, 0xffff0000, v62
    v_mul_f32 v10, v10, v120
    v_mul_f32 v11, v11, v121
    v_cvt_pk_bf16_f32 v62, v10, v11
    v_lshlrev_b32 v10, 16, v63
    v_and_b32 v11, 0xffff0000, v63
    v_mul_f32 v10, v10, v122
    v_mul_f32 v11, v11, v123
    v_cvt_pk_bf16_f32 v63, v10, v11
    global_store_dwordx4 v1, v[60:63], s[18:19]
    s_add_u32 s18, s18, 12288
    s_addc_u32 s19, s19, 0
    v_lshlrev_b32 v10, 16, v64
    v_and_b32 v11, 0xffff0000, v64
    v_mul_f32 v10, v10, v116
    v_mul_f32 v11, v11, v117
    v_cvt_pk_bf16_f32 v64, v10, v11
    v_lshlrev_b32 v10, 16, v65
    v_and_b32 v11, 0xffff0000, v65
    v_mul_f32 v10, v10, v118
    v_mul_f32 v11, v11, v119
    v_cvt_pk_bf16_f32 v65, v10, v11
    v_lshlrev_b32 v10, 16, v66
    v_and_b32 v11, 0xffff0000, v66
    v_mul_f32 v10, v10, v120
    v_mul_f32 v11, v11, v121
    v_cvt_pk_bf16_f32 v66, v10, v11
    v_lshlrev_b32 v10, 16, v67
    v_and_b32 v11, 0xffff0000, v67
    v_mul_f32 v10, v10, v122
    v_mul_f32 v11, v11, v123
    v_cvt_pk_bf16_f32 v67, v10, v11
    global_store_dwordx4 v1, v[64:67], s[18:19]
    s_add_u32 s18, s18, 12288
    s_addc_u32 s19, s19, 0
    v_lshlrev_b32 v10, 16, v68
    v_and_b32 v11, 0xffff0000, v68
    v_mul_f32 v10, v10, v116
    v_mul_f32 v11, v11, v117
    v_cvt_pk_bf16_f32 v68, v10, v11
    v_lshlrev_b32 v10, 16, v69
    v_and_b32 v11, 0xffff0000, v69
    v_mul_f32 v10, v10, v118
    v_mul_f32 v11, v11, v119
    v_cvt_pk_bf16_f32 v69, v10, v11
    v_lshlrev_b32 v10, 16, v70
    v_and_b32 v11, 0xffff0000, v70
    v_mul_f32 v10, v10, v120
    v_mul_f32 v11, v11, v121
    v_cvt_pk_bf16_f32 v70, v10, v11
    v_lshlrev_b32 v10, 16, v71
    v_and_b32 v11, 0xffff0000, v71
    v_mul_f32 v10, v10, v122
    v_mul_f32 v11, v11, v123
    v_cvt_pk_bf16_f32 v71, v10, v11
    global_store_dwordx4 v1, v[68:71], s[18:19]
    s_add_u32 s18, s18, 12288
    s_addc_u32 s19, s19, 0
    v_lshlrev_b32 v10, 16, v72
    v_and_b32 v11, 0xffff0000, v72
    v_mul_f32 v10, v10, v116
    v_mul_f32 v11, v11, v117
    v_cvt_pk_bf16_f32 v72, v10, v11
    v_lshlrev_b32 v10, 16, v73
    v_and_b32 v11, 0xffff0000, v73
    v_mul_f32 v10, v10, v118
    v_mul_f32 v11, v11, v119
    v_cvt_pk_bf16_f32 v73, v10, v11
    v_lshlrev_b32 v10, 16, v74
    v_and_b32 v11, 0xffff0000, v74
    v_mul_f32 v10, v10, v120
    v_mul_f32 v11, v11, v121
    v_cvt_pk_bf16_f32 v74, v10, v11
    v_lshlrev_b32 v10, 16, v75
    v_and_b32 v11, 0xffff0000, v75
    v_mul_f32 v10, v10, v122
    v_mul_f32 v11, v11, v123
    v_cvt_pk_bf16_f32 v75, v10, v11
    global_store_dwordx4 v1, v[72:75], s[18:19]
    s_add_u32 s18, s18, 12288
    s_addc_u32 s19, s19, 0
    v_lshlrev_b32 v10, 16, v76
    v_and_b32 v11, 0xffff0000, v76
    v_mul_f32 v10, v10, v116
    v_mul_f32 v11, v11, v117
    v_cvt_pk_bf16_f32 v76, v10, v11
    v_lshlrev_b32 v10, 16, v77
    v_and_b32 v11, 0xffff0000, v77
    v_mul_f32 v10, v10, v118
    v_mul_f32 v11, v11, v119
    v_cvt_pk_bf16_f32 v77, v10, v11
    v_lshlrev_b32 v10, 16, v78
    v_and_b32 v11, 0xffff0000, v78
    v_mul_f32 v10, v10, v120
    v_mul_f32 v11, v11, v121
    v_cvt_pk_bf16_f32 v78, v10, v11
    v_lshlrev_b32 v10, 16, v79
    v_and_b32 v11, 0xffff0000, v79
    v_mul_f32 v10, v10, v122
    v_mul_f32 v11, v11, v123
    v_cvt_pk_bf16_f32 v79, v10, v11
    global_store_dwordx4 v1, v[76:79], s[18:19]
    s_memtime s[74:75]
    s_waitcnt vmcnt(0)
    s_memtime s[76:77]
    s_cmp_lg_u32 s2, 0
    s_cbranch_scc1 L_end
    s_cmp_lg_u32 s20, 0
    s_cbranch_scc1 L_end
    s_waitcnt lgkmcnt(0)
    s_sub_u32 s22, s66, s64
    v_mov_b32 v10, s22
    v_mov_b32 v14, 0
    global_store_dword v14, v10, s[12:13] offset:4
    s_sub_u32 s22, s68, s64
    v_mov_b32 v10, s22
    v_mov_b32 v14, 0
    global_store_dword v14, v10, s[12:13] offset:8
    s_sub_u32 s22, s70, s64
    v_mov_b32 v10, s22
    v_mov_b32 v14, 0
    global_store_dword v14, v10, s[12:13] offset:12
    s_sub_u32 s22, s72, s64
    v_mov_b32 v10, s22
    v_mov_b32 v14, 0
    global_store_dword v14, v10, s[12:13] offset:16
    s_sub_u32 s22, s74, s64
    v_mov_b32 v10, s22
    v_mov_b32 v14, 0
    global_store_dword v14, v10, s[12:13] offset:20
    s_sub_u32 s22, s76, s64
    v_mov_b32 v10, s22
    v_mov_b32 v14, 0
    global_store_dword v14, v10, s[12:13] offset:24
L_end:
    s_endpgm
.section .rodata,"a"
.p2align 6
.amdhsa_kernel standalone__channel_attn_se__vision_kernel
  .amdhsa_next_free_vgpr 128
  .amdhsa_next_free_sgpr 96
  .amdhsa_accum_offset 128
  .amdhsa_group_segment_fixed_size 0
  .amdhsa_kernarg_size 48
  .amdhsa_user_sgpr_count 2
  .amdhsa_user_sgpr_kernarg_segment_ptr 1
  .amdhsa_system_sgpr_workgroup_id_x 1
  .amdhsa_float_denorm_mode_32 3
.end_amdhsa_kernel
```

```asm
; @launch grid=(256,1,1) block=(768,1,1) lds=32768
.amdgcn_target "amdgcn-amd-amdhsa--gfx950"
.text
.globl standalone__channel_attn_se__vision_kernel
.p2align 8
.type standalone__channel_attn_se__vision_kernel,@function
standalone__channel_attn_se__vision_kernel:
    s_cmp_ge_u32 s2, 256
    s_cbranch_scc1 L_end
    s_load_dwordx4 s[4:7], s[0:1], 0
    s_load_dwordx4 s[8:11], s[0:1], 16
    s_load_dwordx4 s[12:15], s[0:1], 32
    v_lshrrev_b32 v10, 6, v0
    v_lshlrev_b32 v1, 4, v0
    v_readfirstlane_b32 s20, v10
    s_mul_i32 s3, s2, 196608
    s_and_b32 s22, s2, 7
    s_mul_i32 s22, s22, 1536
    s_mov_b32 s21, 0
    s_waitcnt lgkmcnt(0)
    s_add_u32 s16, s4, s3
    s_addc_u32 s17, s5, 0
    s_add_u32 s18, s10, s3
    s_addc_u32 s19, s11, 0
    s_add_u32 s24, s14, s22
    s_addc_u32 s25, s15, 0
    s_memtime s[64:65]
    s_cmp_lg_u32 s2, 0
    s_cbranch_scc1 L_nozero
    s_cmp_lg_u32 s20, 11
    s_cbranch_scc1 L_nozero
    v_mov_b32 v10, 0
    v_mov_b32 v11, 0
    v_mov_b32 v12, 0
    v_mov_b32 v13, 0
    v_and_b32 v14, 63, v0
    v_lshlrev_b32 v14, 4, v14
    global_store_dwordx4 v14, v[10:13], s[14:15] offset:0 sc1
    global_store_dwordx4 v14, v[10:13], s[14:15] offset:1024 sc1
    global_store_dwordx4 v14, v[10:13], s[14:15] offset:2048 sc1
    global_store_dwordx4 v14, v[10:13], s[14:15] offset:3072 sc1
    v_add_u32 v14, 4096, v14
    global_store_dwordx4 v14, v[10:13], s[14:15] offset:0 sc1
    global_store_dwordx4 v14, v[10:13], s[14:15] offset:1024 sc1
    global_store_dwordx4 v14, v[10:13], s[14:15] offset:2048 sc1
    global_store_dwordx4 v14, v[10:13], s[14:15] offset:3072 sc1
    v_add_u32 v14, 4096, v14
    global_store_dwordx4 v14, v[10:13], s[14:15] offset:0 sc1
    global_store_dwordx4 v14, v[10:13], s[14:15] offset:1024 sc1
    global_store_dwordx4 v14, v[10:13], s[14:15] offset:2048 sc1
    global_store_dwordx4 v14, v[10:13], s[14:15] offset:3072 sc1
    s_waitcnt vmcnt(0)
    v_mov_b32 v10, 1
    v_mov_b32 v14, 0
    global_store_dword v14, v10, s[12:13] sc1
L_nozero:
    global_load_dwordx4 v[16:19], v1, s[16:17]
    s_add_u32 s16, s16, 12288
    s_addc_u32 s17, s17, 0
    global_load_dwordx4 v[20:23], v1, s[16:17]
    s_add_u32 s16, s16, 12288
    s_addc_u32 s17, s17, 0
    global_load_dwordx4 v[24:27], v1, s[16:17]
    s_add_u32 s16, s16, 12288
    s_addc_u32 s17, s17, 0
    global_load_dwordx4 v[28:31], v1, s[16:17]
    s_add_u32 s16, s16, 12288
    s_addc_u32 s17, s17, 0
    global_load_dwordx4 v[32:35], v1, s[16:17]
    s_add_u32 s16, s16, 12288
    s_addc_u32 s17, s17, 0
    global_load_dwordx4 v[36:39], v1, s[16:17]
    s_add_u32 s16, s16, 12288
    s_addc_u32 s17, s17, 0
    global_load_dwordx4 v[40:43], v1, s[16:17]
    s_add_u32 s16, s16, 12288
    s_addc_u32 s17, s17, 0
    global_load_dwordx4 v[44:47], v1, s[16:17]
    s_add_u32 s16, s16, 12288
    s_addc_u32 s17, s17, 0
    global_load_dwordx4 v[48:51], v1, s[16:17]
    s_add_u32 s16, s16, 12288
    s_addc_u32 s17, s17, 0
    global_load_dwordx4 v[52:55], v1, s[16:17]
    s_add_u32 s16, s16, 12288
    s_addc_u32 s17, s17, 0
    global_load_dwordx4 v[56:59], v1, s[16:17]
    s_add_u32 s16, s16, 12288
    s_addc_u32 s17, s17, 0
    global_load_dwordx4 v[60:63], v1, s[16:17]
    s_add_u32 s16, s16, 12288
    s_addc_u32 s17, s17, 0
    global_load_dwordx4 v[64:67], v1, s[16:17]
    s_add_u32 s16, s16, 12288
    s_addc_u32 s17, s17, 0
    global_load_dwordx4 v[68:71], v1, s[16:17]
    s_add_u32 s16, s16, 12288
    s_addc_u32 s17, s17, 0
    global_load_dwordx4 v[72:75], v1, s[16:17]
    s_add_u32 s16, s16, 12288
    s_addc_u32 s17, s17, 0
    global_load_dwordx4 v[76:79], v1, s[16:17]
    v_mul_u32_u24 v10, 2731, v0
    v_lshrrev_b32 v10, 16, v10
    v_mul_u32_u24 v11, 24, v10
    v_sub_u32 v11, v0, v11
    v_mul_u32_u24 v124, 576, v10
    v_lshl_add_u32 v124, v11, 1, v124
    v_mul_u32_u24 v127, 48, v10
    v_lshlrev_b32 v126, 2, v11
    global_load_ushort v80, v124, s[6:7] offset:0
    global_load_ushort v81, v124, s[6:7] offset:48
    global_load_ushort v82, v124, s[6:7] offset:96
    global_load_ushort v83, v124, s[6:7] offset:144
    global_load_ushort v84, v124, s[6:7] offset:192
    global_load_ushort v85, v124, s[6:7] offset:240
    global_load_ushort v86, v124, s[6:7] offset:288
    global_load_ushort v87, v124, s[6:7] offset:336
    global_load_ushort v88, v124, s[6:7] offset:384
    global_load_ushort v89, v124, s[6:7] offset:432
    global_load_ushort v90, v124, s[6:7] offset:480
    global_load_ushort v91, v124, s[6:7] offset:528
    v_subrev_u32 v125, 384, v0
    v_cmp_gt_u32 vcc, 384, v0
    s_nop 1
    v_cndmask_b32 v125, v125, v0, vcc
    v_lshlrev_b32 v125, 1, v125
    global_load_ushort v92, v125, s[8:9] offset:0
    global_load_ushort v93, v125, s[8:9] offset:768
    global_load_ushort v94, v125, s[8:9] offset:1536
    global_load_ushort v95, v125, s[8:9] offset:2304
    global_load_ushort v96, v125, s[8:9] offset:3072
    v_add_u32 v125, 3840, v125
    global_load_ushort v97, v125, s[8:9] offset:0
    global_load_ushort v98, v125, s[8:9] offset:768
    global_load_ushort v99, v125, s[8:9] offset:1536
    global_load_ushort v100, v125, s[8:9] offset:2304
    global_load_ushort v101, v125, s[8:9] offset:3072
    v_add_u32 v125, 3840, v125
    global_load_ushort v102, v125, s[8:9] offset:0
    global_load_ushort v103, v125, s[8:9] offset:768
    global_load_ushort v104, v125, s[8:9] offset:1536
    global_load_ushort v105, v125, s[8:9] offset:2304
    global_load_ushort v106, v125, s[8:9] offset:3072
    v_add_u32 v125, 3840, v125
    global_load_ushort v107, v125, s[8:9] offset:0
    global_load_ushort v108, v125, s[8:9] offset:768
    global_load_ushort v109, v125, s[8:9] offset:1536
    global_load_ushort v110, v125, s[8:9] offset:2304
    global_load_ushort v111, v125, s[8:9] offset:3072
    v_add_u32 v125, 3840, v125
    global_load_ushort v112, v125, s[8:9] offset:0
    global_load_ushort v113, v125, s[8:9] offset:768
    global_load_ushort v114, v125, s[8:9] offset:1536
    global_load_ushort v115, v125, s[8:9] offset:2304
    v_and_b32 v10, 31, v0
    v_lshlrev_b32 v10, 2, v10
    v_mov_b32 v11, 0
    ds_write_b32 v10, v11 offset:26112
    v_mov_b32 v2, 0
    v_mov_b32 v3, 0
    v_mov_b32 v4, 0
    v_mov_b32 v5, 0
    v_mov_b32 v6, 0
    v_mov_b32 v7, 0
    v_mov_b32 v8, 0
    v_mov_b32 v9, 0
    s_waitcnt vmcnt(51)
    s_memtime s[66:67]
    v_lshlrev_b32 v10, 16, v16
    v_and_b32 v11, 0xffff0000, v16
    v_add_f32 v2, v2, v10
    v_add_f32 v3, v3, v11
    v_lshlrev_b32 v10, 16, v17
    v_and_b32 v11, 0xffff0000, v17
    v_add_f32 v4, v4, v10
    v_add_f32 v5, v5, v11
    v_lshlrev_b32 v10, 16, v18
    v_and_b32 v11, 0xffff0000, v18
    v_add_f32 v6, v6, v10
    v_add_f32 v7, v7, v11
    v_lshlrev_b32 v10, 16, v19
    v_and_b32 v11, 0xffff0000, v19
    v_add_f32 v8, v8, v10
    v_add_f32 v9, v9, v11
    s_waitcnt vmcnt(50)
    v_lshlrev_b32 v10, 16, v20
    v_and_b32 v11, 0xffff0000, v20
    v_add_f32 v2, v2, v10
    v_add_f32 v3, v3, v11
    v_lshlrev_b32 v10, 16, v21
    v_and_b32 v11, 0xffff0000, v21
    v_add_f32 v4, v4, v10
    v_add_f32 v5, v5, v11
    v_lshlrev_b32 v10, 16, v22
    v_and_b32 v11, 0xffff0000, v22
    v_add_f32 v6, v6, v10
    v_add_f32 v7, v7, v11
    v_lshlrev_b32 v10, 16, v23
    v_and_b32 v11, 0xffff0000, v23
    v_add_f32 v8, v8, v10
    v_add_f32 v9, v9, v11
    s_waitcnt vmcnt(49)
    v_lshlrev_b32 v10, 16, v24
    v_and_b32 v11, 0xffff0000, v24
    v_add_f32 v2, v2, v10
    v_add_f32 v3, v3, v11
    v_lshlrev_b32 v10, 16, v25
    v_and_b32 v11, 0xffff0000, v25
    v_add_f32 v4, v4, v10
    v_add_f32 v5, v5, v11
    v_lshlrev_b32 v10, 16, v26
    v_and_b32 v11, 0xffff0000, v26
    v_add_f32 v6, v6, v10
    v_add_f32 v7, v7, v11
    v_lshlrev_b32 v10, 16, v27
    v_and_b32 v11, 0xffff0000, v27
    v_add_f32 v8, v8, v10
    v_add_f32 v9, v9, v11
    s_waitcnt vmcnt(48)
    v_lshlrev_b32 v10, 16, v28
    v_and_b32 v11, 0xffff0000, v28
    v_add_f32 v2, v2, v10
    v_add_f32 v3, v3, v11
    v_lshlrev_b32 v10, 16, v29
    v_and_b32 v11, 0xffff0000, v29
    v_add_f32 v4, v4, v10
    v_add_f32 v5, v5, v11
    v_lshlrev_b32 v10, 16, v30
    v_and_b32 v11, 0xffff0000, v30
    v_add_f32 v6, v6, v10
    v_add_f32 v7, v7, v11
    v_lshlrev_b32 v10, 16, v31
    v_and_b32 v11, 0xffff0000, v31
    v_add_f32 v8, v8, v10
    v_add_f32 v9, v9, v11
    s_waitcnt vmcnt(47)
    v_lshlrev_b32 v10, 16, v32
    v_and_b32 v11, 0xffff0000, v32
    v_add_f32 v2, v2, v10
    v_add_f32 v3, v3, v11
    v_lshlrev_b32 v10, 16, v33
    v_and_b32 v11, 0xffff0000, v33
    v_add_f32 v4, v4, v10
    v_add_f32 v5, v5, v11
    v_lshlrev_b32 v10, 16, v34
    v_and_b32 v11, 0xffff0000, v34
    v_add_f32 v6, v6, v10
    v_add_f32 v7, v7, v11
    v_lshlrev_b32 v10, 16, v35
    v_and_b32 v11, 0xffff0000, v35
    v_add_f32 v8, v8, v10
    v_add_f32 v9, v9, v11
    s_waitcnt vmcnt(46)
    v_lshlrev_b32 v10, 16, v36
    v_and_b32 v11, 0xffff0000, v36
    v_add_f32 v2, v2, v10
    v_add_f32 v3, v3, v11
    v_lshlrev_b32 v10, 16, v37
    v_and_b32 v11, 0xffff0000, v37
    v_add_f32 v4, v4, v10
    v_add_f32 v5, v5, v11
    v_lshlrev_b32 v10, 16, v38
    v_and_b32 v11, 0xffff0000, v38
    v_add_f32 v6, v6, v10
    v_add_f32 v7, v7, v11
    v_lshlrev_b32 v10, 16, v39
    v_and_b32 v11, 0xffff0000, v39
    v_add_f32 v8, v8, v10
    v_add_f32 v9, v9, v11
    s_waitcnt vmcnt(45)
    v_lshlrev_b32 v10, 16, v40
    v_and_b32 v11, 0xffff0000, v40
    v_add_f32 v2, v2, v10
    v_add_f32 v3, v3, v11
    v_lshlrev_b32 v10, 16, v41
    v_and_b32 v11, 0xffff0000, v41
    v_add_f32 v4, v4, v10
    v_add_f32 v5, v5, v11
    v_lshlrev_b32 v10, 16, v42
    v_and_b32 v11, 0xffff0000, v42
    v_add_f32 v6, v6, v10
    v_add_f32 v7, v7, v11
    v_lshlrev_b32 v10, 16, v43
    v_and_b32 v11, 0xffff0000, v43
    v_add_f32 v8, v8, v10
    v_add_f32 v9, v9, v11
    s_waitcnt vmcnt(44)
    s_memtime s[68:69]
    v_lshlrev_b32 v10, 16, v44
    v_and_b32 v11, 0xffff0000, v44
    v_add_f32 v2, v2, v10
    v_add_f32 v3, v3, v11
    v_lshlrev_b32 v10, 16, v45
    v_and_b32 v11, 0xffff0000, v45
    v_add_f32 v4, v4, v10
    v_add_f32 v5, v5, v11
    v_lshlrev_b32 v10, 16, v46
    v_and_b32 v11, 0xffff0000, v46
    v_add_f32 v6, v6, v10
    v_add_f32 v7, v7, v11
    v_lshlrev_b32 v10, 16, v47
    v_and_b32 v11, 0xffff0000, v47
    v_add_f32 v8, v8, v10
    v_add_f32 v9, v9, v11
    s_waitcnt vmcnt(43)
    v_lshlrev_b32 v10, 16, v48
    v_and_b32 v11, 0xffff0000, v48
    v_add_f32 v2, v2, v10
    v_add_f32 v3, v3, v11
    v_lshlrev_b32 v10, 16, v49
    v_and_b32 v11, 0xffff0000, v49
    v_add_f32 v4, v4, v10
    v_add_f32 v5, v5, v11
    v_lshlrev_b32 v10, 16, v50
    v_and_b32 v11, 0xffff0000, v50
    v_add_f32 v6, v6, v10
    v_add_f32 v7, v7, v11
    v_lshlrev_b32 v10, 16, v51
    v_and_b32 v11, 0xffff0000, v51
    v_add_f32 v8, v8, v10
    v_add_f32 v9, v9, v11
    s_waitcnt vmcnt(42)
    v_lshlrev_b32 v10, 16, v52
    v_and_b32 v11, 0xffff0000, v52
    v_add_f32 v2, v2, v10
    v_add_f32 v3, v3, v11
    v_lshlrev_b32 v10, 16, v53
    v_and_b32 v11, 0xffff0000, v53
    v_add_f32 v4, v4, v10
    v_add_f32 v5, v5, v11
    v_lshlrev_b32 v10, 16, v54
    v_and_b32 v11, 0xffff0000, v54
    v_add_f32 v6, v6, v10
    v_add_f32 v7, v7, v11
    v_lshlrev_b32 v10, 16, v55
    v_and_b32 v11, 0xffff0000, v55
    v_add_f32 v8, v8, v10
    v_add_f32 v9, v9, v11
    s_waitcnt vmcnt(41)
    v_lshlrev_b32 v10, 16, v56
    v_and_b32 v11, 0xffff0000, v56
    v_add_f32 v2, v2, v10
    v_add_f32 v3, v3, v11
    v_lshlrev_b32 v10, 16, v57
    v_and_b32 v11, 0xffff0000, v57
    v_add_f32 v4, v4, v10
    v_add_f32 v5, v5, v11
    v_lshlrev_b32 v10, 16, v58
    v_and_b32 v11, 0xffff0000, v58
    v_add_f32 v6, v6, v10
    v_add_f32 v7, v7, v11
    v_lshlrev_b32 v10, 16, v59
    v_and_b32 v11, 0xffff0000, v59
    v_add_f32 v8, v8, v10
    v_add_f32 v9, v9, v11
    s_waitcnt vmcnt(40)
    v_lshlrev_b32 v10, 16, v60
    v_and_b32 v11, 0xffff0000, v60
    v_add_f32 v2, v2, v10
    v_add_f32 v3, v3, v11
    v_lshlrev_b32 v10, 16, v61
    v_and_b32 v11, 0xffff0000, v61
    v_add_f32 v4, v4, v10
    v_add_f32 v5, v5, v11
    v_lshlrev_b32 v10, 16, v62
    v_and_b32 v11, 0xffff0000, v62
    v_add_f32 v6, v6, v10
    v_add_f32 v7, v7, v11
    v_lshlrev_b32 v10, 16, v63
    v_and_b32 v11, 0xffff0000, v63
    v_add_f32 v8, v8, v10
    v_add_f32 v9, v9, v11
    s_waitcnt vmcnt(39)
    v_lshlrev_b32 v10, 16, v64
    v_and_b32 v11, 0xffff0000, v64
    v_add_f32 v2, v2, v10
    v_add_f32 v3, v3, v11
    v_lshlrev_b32 v10, 16, v65
    v_and_b32 v11, 0xffff0000, v65
    v_add_f32 v4, v4, v10
    v_add_f32 v5, v5, v11
    v_lshlrev_b32 v10, 16, v66
    v_and_b32 v11, 0xffff0000, v66
    v_add_f32 v6, v6, v10
    v_add_f32 v7, v7, v11
    v_lshlrev_b32 v10, 16, v67
    v_and_b32 v11, 0xffff0000, v67
    v_add_f32 v8, v8, v10
    v_add_f32 v9, v9, v11
    s_waitcnt vmcnt(38)
    v_lshlrev_b32 v10, 16, v68
    v_and_b32 v11, 0xffff0000, v68
    v_add_f32 v2, v2, v10
    v_add_f32 v3, v3, v11
    v_lshlrev_b32 v10, 16, v69
    v_and_b32 v11, 0xffff0000, v69
    v_add_f32 v4, v4, v10
    v_add_f32 v5, v5, v11
    v_lshlrev_b32 v10, 16, v70
    v_and_b32 v11, 0xffff0000, v70
    v_add_f32 v6, v6, v10
    v_add_f32 v7, v7, v11
    v_lshlrev_b32 v10, 16, v71
    v_and_b32 v11, 0xffff0000, v71
    v_add_f32 v8, v8, v10
    v_add_f32 v9, v9, v11
    s_waitcnt vmcnt(37)
    v_lshlrev_b32 v10, 16, v72
    v_and_b32 v11, 0xffff0000, v72
    v_add_f32 v2, v2, v10
    v_add_f32 v3, v3, v11
    v_lshlrev_b32 v10, 16, v73
    v_and_b32 v11, 0xffff0000, v73
    v_add_f32 v4, v4, v10
    v_add_f32 v5, v5, v11
    v_lshlrev_b32 v10, 16, v74
    v_and_b32 v11, 0xffff0000, v74
    v_add_f32 v6, v6, v10
    v_add_f32 v7, v7, v11
    v_lshlrev_b32 v10, 16, v75
    v_and_b32 v11, 0xffff0000, v75
    v_add_f32 v8, v8, v10
    v_add_f32 v9, v9, v11
    s_waitcnt vmcnt(36)
    v_lshlrev_b32 v10, 16, v76
    v_and_b32 v11, 0xffff0000, v76
    v_add_f32 v2, v2, v10
    v_add_f32 v3, v3, v11
    v_lshlrev_b32 v10, 16, v77
    v_and_b32 v11, 0xffff0000, v77
    v_add_f32 v4, v4, v10
    v_add_f32 v5, v5, v11
    v_lshlrev_b32 v10, 16, v78
    v_and_b32 v11, 0xffff0000, v78
    v_add_f32 v6, v6, v10
    v_add_f32 v7, v7, v11
    v_lshlrev_b32 v10, 16, v79
    v_and_b32 v11, 0xffff0000, v79
    v_add_f32 v8, v8, v10
    v_add_f32 v9, v9, v11
    v_lshlrev_b32 v10, 5, v0
    ds_write_b128 v10, v[2:5] offset:0
    ds_write_b128 v10, v[6:9] offset:16
    s_cmp_lg_u32 s20, 0
    s_cbranch_scc1 L_flag_ok
    v_mov_b32 v14, 0
L_flag:
    global_load_dword v10, v14, s[12:13] sc1
    s_waitcnt vmcnt(0)
    v_readfirstlane_b32 s22, v10
    s_cmp_lg_u32 s22, 0
    s_cbranch_scc1 L_flag_ok
    s_sleep 1
    s_add_u32 s21, s21, 1
    s_cmp_lt_u32 s21, 200000
    s_cbranch_scc1 L_flag
L_flag_ok:
    s_waitcnt lgkmcnt(0)
    s_memtime s[70:71]
    s_barrier
    s_cmp_ge_u32 s20, 6
    s_cbranch_scc1 L_skip_atomic
    v_lshlrev_b32 v14, 2, v0
    ds_read_b32 v116, v14 offset:0
    ds_read_b32 v117, v14 offset:1536
    ds_read_b32 v118, v14 offset:3072
    ds_read_b32 v119, v14 offset:4608
    ds_read_b32 v120, v14 offset:6144
    ds_read_b32 v121, v14 offset:7680
    ds_read_b32 v122, v14 offset:9216
    ds_read_b32 v123, v14 offset:10752
    ds_read_b32 v10, v14 offset:12288
    ds_read_b32 v11, v14 offset:13824
    ds_read_b32 v12, v14 offset:15360
    ds_read_b32 v13, v14 offset:16896
    ds_read_b32 v2, v14 offset:18432
    ds_read_b32 v3, v14 offset:19968
    ds_read_b32 v4, v14 offset:21504
    ds_read_b32 v5, v14 offset:23040
    s_waitcnt lgkmcnt(0)
    v_add_f32 v116, v116, v117
    v_add_f32 v118, v118, v119
    v_add_f32 v120, v120, v121
    v_add_f32 v122, v122, v123
    v_add_f32 v10, v10, v11
    v_add_f32 v12, v12, v13
    v_add_f32 v2, v2, v3
    v_add_f32 v4, v4, v5
    v_add_f32 v116, v116, v118
    v_add_f32 v120, v120, v122
    v_add_f32 v10, v10, v12
    v_add_f32 v2, v2, v4
    v_add_f32 v116, v116, v120
    v_add_f32 v10, v10, v2
    v_add_f32 v116, v116, v10
    global_atomic_add_f32 v14, v116, s[24:25]
    s_waitcnt vmcnt(0)
L_skip_atomic:
    s_barrier
    s_memtime s[72:73]
    s_cmp_lg_u32 s20, 0
    s_cbranch_scc1 L_arrived
    v_mov_b32 v14, 0
    v_mov_b32 v10, 1
    s_mov_b64 s[28:29], exec
    s_mov_b64 exec, 1
    global_atomic_add v14, v10, s[12:13] offset:128
    s_mov_b64 exec, s[28:29]
L_poll:
    global_load_dword v10, v14, s[12:13] offset:128 sc1
    s_waitcnt vmcnt(0)
    v_readfirstlane_b32 s22, v10
    s_cmp_ge_u32 s22, 256
    s_cbranch_scc1 L_arrived
    s_sleep 1
    s_add_u32 s21, s21, 1
    s_cmp_lt_u32 s21, 200000
    s_cbranch_scc1 L_poll
L_arrived:
    s_barrier
    s_memtime s[74:75]
    s_cmp_ge_u32 s20, 6
    s_cbranch_scc1 L_skip_mean
    v_lshlrev_b32 v14, 2, v0
    global_load_dword v116, v14, s[14:15] offset:0 sc1
    global_load_dword v117, v14, s[14:15] offset:1536 sc1
    v_add_u32 v14, 3072, v14
    global_load_dword v118, v14, s[14:15] offset:0 sc1
    global_load_dword v119, v14, s[14:15] offset:1536 sc1
    v_add_u32 v14, 3072, v14
    global_load_dword v120, v14, s[14:15] offset:0 sc1
    global_load_dword v121, v14, s[14:15] offset:1536 sc1
    v_add_u32 v14, 3072, v14
    global_load_dword v122, v14, s[14:15] offset:0 sc1
    global_load_dword v123, v14, s[14:15] offset:1536 sc1
    s_waitcnt vmcnt(0)
    v_add_f32 v116, v116, v117
    v_add_f32 v118, v118, v119
    v_add_f32 v120, v120, v121
    v_add_f32 v122, v122, v123
    v_add_f32 v116, v116, v118
    v_add_f32 v120, v120, v122
    v_add_f32 v116, v116, v120
    v_mul_f32 v10, 0x37800000, v116
    v_cvt_pk_bf16_f32 v10, v10, v10
    v_lshlrev_b32 v10, 16, v10
    v_lshlrev_b32 v14, 2, v0
    ds_write_b32 v14, v10 offset:24576
    s_waitcnt lgkmcnt(0)
L_skip_mean:
    s_barrier
    ds_read_b128 v[116:119], v127 offset:24576
    ds_read_b128 v[120:123], v127 offset:24592
    ds_read_b128 v[10:13], v127 offset:24608
    v_lshlrev_b32 v80, 16, v80
    v_lshlrev_b32 v81, 16, v81
    v_lshlrev_b32 v82, 16, v82
    v_lshlrev_b32 v83, 16, v83
    v_lshlrev_b32 v84, 16, v84
    v_lshlrev_b32 v85, 16, v85
    v_lshlrev_b32 v86, 16, v86
    v_lshlrev_b32 v87, 16, v87
    v_lshlrev_b32 v88, 16, v88
    v_lshlrev_b32 v89, 16, v89
    v_lshlrev_b32 v90, 16, v90
    v_lshlrev_b32 v91, 16, v91
    v_lshlrev_b32 v92, 16, v92
    v_lshlrev_b32 v93, 16, v93
    v_lshlrev_b32 v94, 16, v94
    v_lshlrev_b32 v95, 16, v95
    v_lshlrev_b32 v96, 16, v96
    v_lshlrev_b32 v97, 16, v97
    v_lshlrev_b32 v98, 16, v98
    v_lshlrev_b32 v99, 16, v99
    v_lshlrev_b32 v100, 16, v100
    v_lshlrev_b32 v101, 16, v101
    v_lshlrev_b32 v102, 16, v102
    v_lshlrev_b32 v103, 16, v103
    v_lshlrev_b32 v104, 16, v104
    v_lshlrev_b32 v105, 16, v105
    v_lshlrev_b32 v106, 16, v106
    v_lshlrev_b32 v107, 16, v107
    v_lshlrev_b32 v108, 16, v108
    v_lshlrev_b32 v109, 16, v109
    v_lshlrev_b32 v110, 16, v110
    v_lshlrev_b32 v111, 16, v111
    v_lshlrev_b32 v112, 16, v112
    v_lshlrev_b32 v113, 16, v113
    v_lshlrev_b32 v114, 16, v114
    v_lshlrev_b32 v115, 16, v115
    s_waitcnt lgkmcnt(0)
    v_mul_f32 v14, v116, v80
    v_fmac_f32 v14, v117, v81
    v_fmac_f32 v14, v118, v82
    v_fmac_f32 v14, v119, v83
    v_fmac_f32 v14, v120, v84
    v_fmac_f32 v14, v121, v85
    v_fmac_f32 v14, v122, v86
    v_fmac_f32 v14, v123, v87
    v_fmac_f32 v14, v10, v88
    v_fmac_f32 v14, v11, v89
    v_fmac_f32 v14, v12, v90
    v_fmac_f32 v14, v13, v91
    ds_add_f32 v126, v14 offset:26112
    s_waitcnt lgkmcnt(0)
    s_barrier
    v_and_b32 v10, 31, v0
    v_lshlrev_b32 v10, 2, v10
    ds_read_b32 v10, v10 offset:26112
    s_waitcnt lgkmcnt(0)
    v_cvt_pk_bf16_f32 v10, v10, v10
    v_lshlrev_b32 v10, 16, v10
    v_mul_f32 v11, 0xbfb8aa3b, v10
    v_exp_f32 v11, v11
    s_nop 0
    v_add_f32 v11, 1.0, v11
    v_rcp_f32 v11, v11
    s_nop 0
    v_mul_f32 v10, v10, v11
    v_cvt_pk_bf16_f32 v10, v10, v10
    v_lshlrev_b32 v10, 16, v10
    s_nop 0
    v_readlane_b32 s40, v10, 0
    v_readlane_b32 s41, v10, 1
    v_readlane_b32 s42, v10, 2
    v_readlane_b32 s43, v10, 3
    v_readlane_b32 s44, v10, 4
    v_readlane_b32 s45, v10, 5
    v_readlane_b32 s46, v10, 6
    v_readlane_b32 s47, v10, 7
    v_readlane_b32 s48, v10, 8
    v_readlane_b32 s49, v10, 9
    v_readlane_b32 s50, v10, 10
    v_readlane_b32 s51, v10, 11
    v_readlane_b32 s52, v10, 12
    v_readlane_b32 s53, v10, 13
    v_readlane_b32 s54, v10, 14
    v_readlane_b32 s55, v10, 15
    v_readlane_b32 s56, v10, 16
    v_readlane_b32 s57, v10, 17
    v_readlane_b32 s58, v10, 18
    v_readlane_b32 s59, v10, 19
    v_readlane_b32 s60, v10, 20
    v_readlane_b32 s61, v10, 21
    v_readlane_b32 s62, v10, 22
    v_readlane_b32 s63, v10, 23
    s_nop 1
    v_mul_f32 v14, s40, v92
    v_fmac_f32 v14, s41, v93
    v_fmac_f32 v14, s42, v94
    v_fmac_f32 v14, s43, v95
    v_fmac_f32 v14, s44, v96
    v_fmac_f32 v14, s45, v97
    v_fmac_f32 v14, s46, v98
    v_fmac_f32 v14, s47, v99
    v_fmac_f32 v14, s48, v100
    v_fmac_f32 v14, s49, v101
    v_fmac_f32 v14, s50, v102
    v_fmac_f32 v14, s51, v103
    v_fmac_f32 v14, s52, v104
    v_fmac_f32 v14, s53, v105
    v_fmac_f32 v14, s54, v106
    v_fmac_f32 v14, s55, v107
    v_fmac_f32 v14, s56, v108
    v_fmac_f32 v14, s57, v109
    v_fmac_f32 v14, s58, v110
    v_fmac_f32 v14, s59, v111
    v_fmac_f32 v14, s60, v112
    v_fmac_f32 v14, s61, v113
    v_fmac_f32 v14, s62, v114
    v_fmac_f32 v14, s63, v115
    v_cvt_pk_bf16_f32 v14, v14, v14
    v_lshlrev_b32 v14, 16, v14
    v_mul_f32 v11, 0xbfb8aa3b, v14
    v_exp_f32 v11, v11
    s_nop 0
    v_add_f32 v11, 1.0, v11
    v_rcp_f32 v11, v11
    s_nop 0
    v_cvt_pk_bf16_f32 v11, v11, v11
    v_lshlrev_b32 v11, 16, v11
    v_subrev_u32 v10, 384, v0
    v_cmp_gt_u32 vcc, 384, v0
    s_nop 1
    v_cndmask_b32 v10, v10, v0, vcc
    v_lshlrev_b32 v10, 2, v10
    ds_write_b32 v10, v11 offset:26240
    s_waitcnt lgkmcnt(0)
    s_barrier
    s_memtime s[76:77]
    v_mul_u32_u24 v10, 1366, v0
    v_lshrrev_b32 v10, 16, v10
    v_mul_u32_u24 v10, 48, v10
    v_sub_u32 v10, v0, v10
    v_lshlrev_b32 v10, 5, v10
    ds_read_b128 v[116:119], v10 offset:26240
    ds_read_b128 v[120:123], v10 offset:26256
    s_waitcnt lgkmcnt(0)
    v_lshlrev_b32 v10, 16, v16
    v_and_b32 v11, 0xffff0000, v16
    v_mul_f32 v10, v10, v116
    v_mul_f32 v11, v11, v117
    v_cvt_pk_bf16_f32 v16, v10, v11
    v_lshlrev_b32 v10, 16, v17
    v_and_b32 v11, 0xffff0000, v17
    v_mul_f32 v10, v10, v118
    v_mul_f32 v11, v11, v119
    v_cvt_pk_bf16_f32 v17, v10, v11
    v_lshlrev_b32 v10, 16, v18
    v_and_b32 v11, 0xffff0000, v18
    v_mul_f32 v10, v10, v120
    v_mul_f32 v11, v11, v121
    v_cvt_pk_bf16_f32 v18, v10, v11
    v_lshlrev_b32 v10, 16, v19
    v_and_b32 v11, 0xffff0000, v19
    v_mul_f32 v10, v10, v122
    v_mul_f32 v11, v11, v123
    v_cvt_pk_bf16_f32 v19, v10, v11
    global_store_dwordx4 v1, v[16:19], s[18:19]
    s_add_u32 s18, s18, 12288
    s_addc_u32 s19, s19, 0
    v_lshlrev_b32 v10, 16, v20
    v_and_b32 v11, 0xffff0000, v20
    v_mul_f32 v10, v10, v116
    v_mul_f32 v11, v11, v117
    v_cvt_pk_bf16_f32 v20, v10, v11
    v_lshlrev_b32 v10, 16, v21
    v_and_b32 v11, 0xffff0000, v21
    v_mul_f32 v10, v10, v118
    v_mul_f32 v11, v11, v119
    v_cvt_pk_bf16_f32 v21, v10, v11
    v_lshlrev_b32 v10, 16, v22
    v_and_b32 v11, 0xffff0000, v22
    v_mul_f32 v10, v10, v120
    v_mul_f32 v11, v11, v121
    v_cvt_pk_bf16_f32 v22, v10, v11
    v_lshlrev_b32 v10, 16, v23
    v_and_b32 v11, 0xffff0000, v23
    v_mul_f32 v10, v10, v122
    v_mul_f32 v11, v11, v123
    v_cvt_pk_bf16_f32 v23, v10, v11
    global_store_dwordx4 v1, v[20:23], s[18:19]
    s_add_u32 s18, s18, 12288
    s_addc_u32 s19, s19, 0
    v_lshlrev_b32 v10, 16, v24
    v_and_b32 v11, 0xffff0000, v24
    v_mul_f32 v10, v10, v116
    v_mul_f32 v11, v11, v117
    v_cvt_pk_bf16_f32 v24, v10, v11
    v_lshlrev_b32 v10, 16, v25
    v_and_b32 v11, 0xffff0000, v25
    v_mul_f32 v10, v10, v118
    v_mul_f32 v11, v11, v119
    v_cvt_pk_bf16_f32 v25, v10, v11
    v_lshlrev_b32 v10, 16, v26
    v_and_b32 v11, 0xffff0000, v26
    v_mul_f32 v10, v10, v120
    v_mul_f32 v11, v11, v121
    v_cvt_pk_bf16_f32 v26, v10, v11
    v_lshlrev_b32 v10, 16, v27
    v_and_b32 v11, 0xffff0000, v27
    v_mul_f32 v10, v10, v122
    v_mul_f32 v11, v11, v123
    v_cvt_pk_bf16_f32 v27, v10, v11
    global_store_dwordx4 v1, v[24:27], s[18:19]
    s_add_u32 s18, s18, 12288
    s_addc_u32 s19, s19, 0
    v_lshlrev_b32 v10, 16, v28
    v_and_b32 v11, 0xffff0000, v28
    v_mul_f32 v10, v10, v116
    v_mul_f32 v11, v11, v117
    v_cvt_pk_bf16_f32 v28, v10, v11
    v_lshlrev_b32 v10, 16, v29
    v_and_b32 v11, 0xffff0000, v29
    v_mul_f32 v10, v10, v118
    v_mul_f32 v11, v11, v119
    v_cvt_pk_bf16_f32 v29, v10, v11
    v_lshlrev_b32 v10, 16, v30
    v_and_b32 v11, 0xffff0000, v30
    v_mul_f32 v10, v10, v120
    v_mul_f32 v11, v11, v121
    v_cvt_pk_bf16_f32 v30, v10, v11
    v_lshlrev_b32 v10, 16, v31
    v_and_b32 v11, 0xffff0000, v31
    v_mul_f32 v10, v10, v122
    v_mul_f32 v11, v11, v123
    v_cvt_pk_bf16_f32 v31, v10, v11
    global_store_dwordx4 v1, v[28:31], s[18:19]
    s_add_u32 s18, s18, 12288
    s_addc_u32 s19, s19, 0
    v_lshlrev_b32 v10, 16, v32
    v_and_b32 v11, 0xffff0000, v32
    v_mul_f32 v10, v10, v116
    v_mul_f32 v11, v11, v117
    v_cvt_pk_bf16_f32 v32, v10, v11
    v_lshlrev_b32 v10, 16, v33
    v_and_b32 v11, 0xffff0000, v33
    v_mul_f32 v10, v10, v118
    v_mul_f32 v11, v11, v119
    v_cvt_pk_bf16_f32 v33, v10, v11
    v_lshlrev_b32 v10, 16, v34
    v_and_b32 v11, 0xffff0000, v34
    v_mul_f32 v10, v10, v120
    v_mul_f32 v11, v11, v121
    v_cvt_pk_bf16_f32 v34, v10, v11
    v_lshlrev_b32 v10, 16, v35
    v_and_b32 v11, 0xffff0000, v35
    v_mul_f32 v10, v10, v122
    v_mul_f32 v11, v11, v123
    v_cvt_pk_bf16_f32 v35, v10, v11
    global_store_dwordx4 v1, v[32:35], s[18:19]
    s_add_u32 s18, s18, 12288
    s_addc_u32 s19, s19, 0
    v_lshlrev_b32 v10, 16, v36
    v_and_b32 v11, 0xffff0000, v36
    v_mul_f32 v10, v10, v116
    v_mul_f32 v11, v11, v117
    v_cvt_pk_bf16_f32 v36, v10, v11
    v_lshlrev_b32 v10, 16, v37
    v_and_b32 v11, 0xffff0000, v37
    v_mul_f32 v10, v10, v118
    v_mul_f32 v11, v11, v119
    v_cvt_pk_bf16_f32 v37, v10, v11
    v_lshlrev_b32 v10, 16, v38
    v_and_b32 v11, 0xffff0000, v38
    v_mul_f32 v10, v10, v120
    v_mul_f32 v11, v11, v121
    v_cvt_pk_bf16_f32 v38, v10, v11
    v_lshlrev_b32 v10, 16, v39
    v_and_b32 v11, 0xffff0000, v39
    v_mul_f32 v10, v10, v122
    v_mul_f32 v11, v11, v123
    v_cvt_pk_bf16_f32 v39, v10, v11
    global_store_dwordx4 v1, v[36:39], s[18:19]
    s_add_u32 s18, s18, 12288
    s_addc_u32 s19, s19, 0
    v_lshlrev_b32 v10, 16, v40
    v_and_b32 v11, 0xffff0000, v40
    v_mul_f32 v10, v10, v116
    v_mul_f32 v11, v11, v117
    v_cvt_pk_bf16_f32 v40, v10, v11
    v_lshlrev_b32 v10, 16, v41
    v_and_b32 v11, 0xffff0000, v41
    v_mul_f32 v10, v10, v118
    v_mul_f32 v11, v11, v119
    v_cvt_pk_bf16_f32 v41, v10, v11
    v_lshlrev_b32 v10, 16, v42
    v_and_b32 v11, 0xffff0000, v42
    v_mul_f32 v10, v10, v120
    v_mul_f32 v11, v11, v121
    v_cvt_pk_bf16_f32 v42, v10, v11
    v_lshlrev_b32 v10, 16, v43
    v_and_b32 v11, 0xffff0000, v43
    v_mul_f32 v10, v10, v122
    v_mul_f32 v11, v11, v123
    v_cvt_pk_bf16_f32 v43, v10, v11
    global_store_dwordx4 v1, v[40:43], s[18:19]
    s_add_u32 s18, s18, 12288
    s_addc_u32 s19, s19, 0
    v_lshlrev_b32 v10, 16, v44
    v_and_b32 v11, 0xffff0000, v44
    v_mul_f32 v10, v10, v116
    v_mul_f32 v11, v11, v117
    v_cvt_pk_bf16_f32 v44, v10, v11
    v_lshlrev_b32 v10, 16, v45
    v_and_b32 v11, 0xffff0000, v45
    v_mul_f32 v10, v10, v118
    v_mul_f32 v11, v11, v119
    v_cvt_pk_bf16_f32 v45, v10, v11
    v_lshlrev_b32 v10, 16, v46
    v_and_b32 v11, 0xffff0000, v46
    v_mul_f32 v10, v10, v120
    v_mul_f32 v11, v11, v121
    v_cvt_pk_bf16_f32 v46, v10, v11
    v_lshlrev_b32 v10, 16, v47
    v_and_b32 v11, 0xffff0000, v47
    v_mul_f32 v10, v10, v122
    v_mul_f32 v11, v11, v123
    v_cvt_pk_bf16_f32 v47, v10, v11
    global_store_dwordx4 v1, v[44:47], s[18:19]
    s_add_u32 s18, s18, 12288
    s_addc_u32 s19, s19, 0
    v_lshlrev_b32 v10, 16, v48
    v_and_b32 v11, 0xffff0000, v48
    v_mul_f32 v10, v10, v116
    v_mul_f32 v11, v11, v117
    v_cvt_pk_bf16_f32 v48, v10, v11
    v_lshlrev_b32 v10, 16, v49
    v_and_b32 v11, 0xffff0000, v49
    v_mul_f32 v10, v10, v118
    v_mul_f32 v11, v11, v119
    v_cvt_pk_bf16_f32 v49, v10, v11
    v_lshlrev_b32 v10, 16, v50
    v_and_b32 v11, 0xffff0000, v50
    v_mul_f32 v10, v10, v120
    v_mul_f32 v11, v11, v121
    v_cvt_pk_bf16_f32 v50, v10, v11
    v_lshlrev_b32 v10, 16, v51
    v_and_b32 v11, 0xffff0000, v51
    v_mul_f32 v10, v10, v122
    v_mul_f32 v11, v11, v123
    v_cvt_pk_bf16_f32 v51, v10, v11
    global_store_dwordx4 v1, v[48:51], s[18:19]
    s_add_u32 s18, s18, 12288
    s_addc_u32 s19, s19, 0
    v_lshlrev_b32 v10, 16, v52
    v_and_b32 v11, 0xffff0000, v52
    v_mul_f32 v10, v10, v116
    v_mul_f32 v11, v11, v117
    v_cvt_pk_bf16_f32 v52, v10, v11
    v_lshlrev_b32 v10, 16, v53
    v_and_b32 v11, 0xffff0000, v53
    v_mul_f32 v10, v10, v118
    v_mul_f32 v11, v11, v119
    v_cvt_pk_bf16_f32 v53, v10, v11
    v_lshlrev_b32 v10, 16, v54
    v_and_b32 v11, 0xffff0000, v54
    v_mul_f32 v10, v10, v120
    v_mul_f32 v11, v11, v121
    v_cvt_pk_bf16_f32 v54, v10, v11
    v_lshlrev_b32 v10, 16, v55
    v_and_b32 v11, 0xffff0000, v55
    v_mul_f32 v10, v10, v122
    v_mul_f32 v11, v11, v123
    v_cvt_pk_bf16_f32 v55, v10, v11
    global_store_dwordx4 v1, v[52:55], s[18:19]
    s_add_u32 s18, s18, 12288
    s_addc_u32 s19, s19, 0
    v_lshlrev_b32 v10, 16, v56
    v_and_b32 v11, 0xffff0000, v56
    v_mul_f32 v10, v10, v116
    v_mul_f32 v11, v11, v117
    v_cvt_pk_bf16_f32 v56, v10, v11
    v_lshlrev_b32 v10, 16, v57
    v_and_b32 v11, 0xffff0000, v57
    v_mul_f32 v10, v10, v118
    v_mul_f32 v11, v11, v119
    v_cvt_pk_bf16_f32 v57, v10, v11
    v_lshlrev_b32 v10, 16, v58
    v_and_b32 v11, 0xffff0000, v58
    v_mul_f32 v10, v10, v120
    v_mul_f32 v11, v11, v121
    v_cvt_pk_bf16_f32 v58, v10, v11
    v_lshlrev_b32 v10, 16, v59
    v_and_b32 v11, 0xffff0000, v59
    v_mul_f32 v10, v10, v122
    v_mul_f32 v11, v11, v123
    v_cvt_pk_bf16_f32 v59, v10, v11
    global_store_dwordx4 v1, v[56:59], s[18:19]
    s_add_u32 s18, s18, 12288
    s_addc_u32 s19, s19, 0
    v_lshlrev_b32 v10, 16, v60
    v_and_b32 v11, 0xffff0000, v60
    v_mul_f32 v10, v10, v116
    v_mul_f32 v11, v11, v117
    v_cvt_pk_bf16_f32 v60, v10, v11
    v_lshlrev_b32 v10, 16, v61
    v_and_b32 v11, 0xffff0000, v61
    v_mul_f32 v10, v10, v118
    v_mul_f32 v11, v11, v119
    v_cvt_pk_bf16_f32 v61, v10, v11
    v_lshlrev_b32 v10, 16, v62
    v_and_b32 v11, 0xffff0000, v62
    v_mul_f32 v10, v10, v120
    v_mul_f32 v11, v11, v121
    v_cvt_pk_bf16_f32 v62, v10, v11
    v_lshlrev_b32 v10, 16, v63
    v_and_b32 v11, 0xffff0000, v63
    v_mul_f32 v10, v10, v122
    v_mul_f32 v11, v11, v123
    v_cvt_pk_bf16_f32 v63, v10, v11
    global_store_dwordx4 v1, v[60:63], s[18:19]
    s_add_u32 s18, s18, 12288
    s_addc_u32 s19, s19, 0
    v_lshlrev_b32 v10, 16, v64
    v_and_b32 v11, 0xffff0000, v64
    v_mul_f32 v10, v10, v116
    v_mul_f32 v11, v11, v117
    v_cvt_pk_bf16_f32 v64, v10, v11
    v_lshlrev_b32 v10, 16, v65
    v_and_b32 v11, 0xffff0000, v65
    v_mul_f32 v10, v10, v118
    v_mul_f32 v11, v11, v119
    v_cvt_pk_bf16_f32 v65, v10, v11
    v_lshlrev_b32 v10, 16, v66
    v_and_b32 v11, 0xffff0000, v66
    v_mul_f32 v10, v10, v120
    v_mul_f32 v11, v11, v121
    v_cvt_pk_bf16_f32 v66, v10, v11
    v_lshlrev_b32 v10, 16, v67
    v_and_b32 v11, 0xffff0000, v67
    v_mul_f32 v10, v10, v122
    v_mul_f32 v11, v11, v123
    v_cvt_pk_bf16_f32 v67, v10, v11
    global_store_dwordx4 v1, v[64:67], s[18:19]
    s_add_u32 s18, s18, 12288
    s_addc_u32 s19, s19, 0
    v_lshlrev_b32 v10, 16, v68
    v_and_b32 v11, 0xffff0000, v68
    v_mul_f32 v10, v10, v116
    v_mul_f32 v11, v11, v117
    v_cvt_pk_bf16_f32 v68, v10, v11
    v_lshlrev_b32 v10, 16, v69
    v_and_b32 v11, 0xffff0000, v69
    v_mul_f32 v10, v10, v118
    v_mul_f32 v11, v11, v119
    v_cvt_pk_bf16_f32 v69, v10, v11
    v_lshlrev_b32 v10, 16, v70
    v_and_b32 v11, 0xffff0000, v70
    v_mul_f32 v10, v10, v120
    v_mul_f32 v11, v11, v121
    v_cvt_pk_bf16_f32 v70, v10, v11
    v_lshlrev_b32 v10, 16, v71
    v_and_b32 v11, 0xffff0000, v71
    v_mul_f32 v10, v10, v122
    v_mul_f32 v11, v11, v123
    v_cvt_pk_bf16_f32 v71, v10, v11
    global_store_dwordx4 v1, v[68:71], s[18:19]
    s_add_u32 s18, s18, 12288
    s_addc_u32 s19, s19, 0
    v_lshlrev_b32 v10, 16, v72
    v_and_b32 v11, 0xffff0000, v72
    v_mul_f32 v10, v10, v116
    v_mul_f32 v11, v11, v117
    v_cvt_pk_bf16_f32 v72, v10, v11
    v_lshlrev_b32 v10, 16, v73
    v_and_b32 v11, 0xffff0000, v73
    v_mul_f32 v10, v10, v118
    v_mul_f32 v11, v11, v119
    v_cvt_pk_bf16_f32 v73, v10, v11
    v_lshlrev_b32 v10, 16, v74
    v_and_b32 v11, 0xffff0000, v74
    v_mul_f32 v10, v10, v120
    v_mul_f32 v11, v11, v121
    v_cvt_pk_bf16_f32 v74, v10, v11
    v_lshlrev_b32 v10, 16, v75
    v_and_b32 v11, 0xffff0000, v75
    v_mul_f32 v10, v10, v122
    v_mul_f32 v11, v11, v123
    v_cvt_pk_bf16_f32 v75, v10, v11
    global_store_dwordx4 v1, v[72:75], s[18:19]
    s_add_u32 s18, s18, 12288
    s_addc_u32 s19, s19, 0
    v_lshlrev_b32 v10, 16, v76
    v_and_b32 v11, 0xffff0000, v76
    v_mul_f32 v10, v10, v116
    v_mul_f32 v11, v11, v117
    v_cvt_pk_bf16_f32 v76, v10, v11
    v_lshlrev_b32 v10, 16, v77
    v_and_b32 v11, 0xffff0000, v77
    v_mul_f32 v10, v10, v118
    v_mul_f32 v11, v11, v119
    v_cvt_pk_bf16_f32 v77, v10, v11
    v_lshlrev_b32 v10, 16, v78
    v_and_b32 v11, 0xffff0000, v78
    v_mul_f32 v10, v10, v120
    v_mul_f32 v11, v11, v121
    v_cvt_pk_bf16_f32 v78, v10, v11
    v_lshlrev_b32 v10, 16, v79
    v_and_b32 v11, 0xffff0000, v79
    v_mul_f32 v10, v10, v122
    v_mul_f32 v11, v11, v123
    v_cvt_pk_bf16_f32 v79, v10, v11
    global_store_dwordx4 v1, v[76:79], s[18:19]
    s_memtime s[78:79]
    s_waitcnt vmcnt(0)
    s_memtime s[80:81]
    s_cmp_lg_u32 s2, 255
    s_cbranch_scc1 L_end
    s_cmp_lg_u32 s20, 0
    s_cbranch_scc1 L_end
    s_waitcnt lgkmcnt(0)
    s_sub_u32 s22, s66, s64
    v_mov_b32 v10, s22
    v_mov_b32 v14, 0
    global_store_dword v14, v10, s[12:13] offset:4
    s_sub_u32 s22, s68, s64
    v_mov_b32 v10, s22
    v_mov_b32 v14, 0
    global_store_dword v14, v10, s[12:13] offset:8
    s_sub_u32 s22, s70, s64
    v_mov_b32 v10, s22
    v_mov_b32 v14, 0
    global_store_dword v14, v10, s[12:13] offset:12
    s_sub_u32 s22, s72, s64
    v_mov_b32 v10, s22
    v_mov_b32 v14, 0
    global_store_dword v14, v10, s[12:13] offset:16
    s_sub_u32 s22, s74, s64
    v_mov_b32 v10, s22
    v_mov_b32 v14, 0
    global_store_dword v14, v10, s[12:13] offset:20
    s_sub_u32 s22, s76, s64
    v_mov_b32 v10, s22
    v_mov_b32 v14, 0
    global_store_dword v14, v10, s[12:13] offset:24
    s_sub_u32 s22, s78, s64
    v_mov_b32 v10, s22
    v_mov_b32 v14, 0
    global_store_dword v14, v10, s[12:13] offset:28
    s_sub_u32 s22, s80, s64
    v_mov_b32 v10, s22
    v_mov_b32 v14, 0
    global_store_dword v14, v10, s[12:13] offset:32
L_end:
    s_endpgm
.section .rodata,"a"
.p2align 6
.amdhsa_kernel standalone__channel_attn_se__vision_kernel
  .amdhsa_next_free_vgpr 128
  .amdhsa_next_free_sgpr 96
  .amdhsa_accum_offset 128
  .amdhsa_group_segment_fixed_size 0
  .amdhsa_kernarg_size 48
  .amdhsa_user_sgpr_count 2
  .amdhsa_user_sgpr_kernarg_segment_ptr 1
  .amdhsa_system_sgpr_workgroup_id_x 1
  .amdhsa_float_denorm_mode_32 3
.end_amdhsa_kernel
```

```asm
; @launch grid=(256,1,1) block=(768,1,1) lds=32768
.amdgcn_target "amdgcn-amd-amdhsa--gfx950"
.text
.globl standalone__channel_attn_se__vision_kernel
.p2align 8
.type standalone__channel_attn_se__vision_kernel,@function
standalone__channel_attn_se__vision_kernel:
    s_cmp_ge_u32 s2, 256
    s_cbranch_scc1 L_end
    s_load_dwordx4 s[4:7], s[0:1], 0
    s_load_dwordx4 s[8:11], s[0:1], 16
    s_load_dwordx4 s[12:15], s[0:1], 32
    v_lshrrev_b32 v10, 6, v0
    v_lshlrev_b32 v1, 4, v0
    v_readfirstlane_b32 s20, v10
    s_mul_i32 s3, s2, 196608
    s_and_b32 s22, s2, 7
    s_mul_i32 s22, s22, 1536
    s_mov_b32 s21, 0
    s_waitcnt lgkmcnt(0)
    s_add_u32 s16, s4, s3
    s_addc_u32 s17, s5, 0
    s_add_u32 s18, s10, s3
    s_addc_u32 s19, s11, 0
    s_add_u32 s24, s14, s22
    s_addc_u32 s25, s15, 0
    s_memtime s[64:65]
    s_cmp_lg_u32 s2, 0
    s_cbranch_scc1 L_nozero
    s_cmp_lg_u32 s20, 11
    s_cbranch_scc1 L_nozero
    v_mov_b32 v10, 0
    v_mov_b32 v11, 0
    v_mov_b32 v12, 0
    v_mov_b32 v13, 0
    v_and_b32 v14, 63, v0
    v_lshlrev_b32 v14, 4, v14
    global_store_dwordx4 v14, v[10:13], s[14:15] offset:0 sc1
    global_store_dwordx4 v14, v[10:13], s[14:15] offset:1024 sc1
    global_store_dwordx4 v14, v[10:13], s[14:15] offset:2048 sc1
    global_store_dwordx4 v14, v[10:13], s[14:15] offset:3072 sc1
    v_add_u32 v14, 4096, v14
    global_store_dwordx4 v14, v[10:13], s[14:15] offset:0 sc1
    global_store_dwordx4 v14, v[10:13], s[14:15] offset:1024 sc1
    global_store_dwordx4 v14, v[10:13], s[14:15] offset:2048 sc1
    global_store_dwordx4 v14, v[10:13], s[14:15] offset:3072 sc1
    v_add_u32 v14, 4096, v14
    global_store_dwordx4 v14, v[10:13], s[14:15] offset:0 sc1
    global_store_dwordx4 v14, v[10:13], s[14:15] offset:1024 sc1
    global_store_dwordx4 v14, v[10:13], s[14:15] offset:2048 sc1
    global_store_dwordx4 v14, v[10:13], s[14:15] offset:3072 sc1
    s_waitcnt vmcnt(0)
    v_mov_b32 v10, 1
    v_mov_b32 v14, 0
    global_store_dword v14, v10, s[12:13] sc1
L_nozero:
    global_load_dwordx4 v[16:19], v1, s[16:17] sc0 sc1 nt
    s_add_u32 s16, s16, 12288
    s_addc_u32 s17, s17, 0
    global_load_dwordx4 v[20:23], v1, s[16:17] sc0 sc1 nt
    s_add_u32 s16, s16, 12288
    s_addc_u32 s17, s17, 0
    global_load_dwordx4 v[24:27], v1, s[16:17] sc0 sc1 nt
    s_add_u32 s16, s16, 12288
    s_addc_u32 s17, s17, 0
    global_load_dwordx4 v[28:31], v1, s[16:17] sc0 sc1 nt
    s_add_u32 s16, s16, 12288
    s_addc_u32 s17, s17, 0
    global_load_dwordx4 v[32:35], v1, s[16:17] sc0 sc1 nt
    s_add_u32 s16, s16, 12288
    s_addc_u32 s17, s17, 0
    global_load_dwordx4 v[36:39], v1, s[16:17] sc0 sc1 nt
    s_add_u32 s16, s16, 12288
    s_addc_u32 s17, s17, 0
    global_load_dwordx4 v[40:43], v1, s[16:17] sc0 sc1 nt
    s_add_u32 s16, s16, 12288
    s_addc_u32 s17, s17, 0
    global_load_dwordx4 v[44:47], v1, s[16:17] sc0 sc1 nt
    s_add_u32 s16, s16, 12288
    s_addc_u32 s17, s17, 0
    global_load_dwordx4 v[48:51], v1, s[16:17] sc0 sc1 nt
    s_add_u32 s16, s16, 12288
    s_addc_u32 s17, s17, 0
    global_load_dwordx4 v[52:55], v1, s[16:17] sc0 sc1 nt
    s_add_u32 s16, s16, 12288
    s_addc_u32 s17, s17, 0
    global_load_dwordx4 v[56:59], v1, s[16:17] sc0 sc1 nt
    s_add_u32 s16, s16, 12288
    s_addc_u32 s17, s17, 0
    global_load_dwordx4 v[60:63], v1, s[16:17] sc0 sc1 nt
    s_add_u32 s16, s16, 12288
    s_addc_u32 s17, s17, 0
    global_load_dwordx4 v[64:67], v1, s[16:17] sc0 sc1 nt
    s_add_u32 s16, s16, 12288
    s_addc_u32 s17, s17, 0
    global_load_dwordx4 v[68:71], v1, s[16:17] sc0 sc1 nt
    s_add_u32 s16, s16, 12288
    s_addc_u32 s17, s17, 0
    global_load_dwordx4 v[72:75], v1, s[16:17] sc0 sc1 nt
    s_add_u32 s16, s16, 12288
    s_addc_u32 s17, s17, 0
    global_load_dwordx4 v[76:79], v1, s[16:17] sc0 sc1 nt
    v_mul_u32_u24 v10, 2731, v0
    v_lshrrev_b32 v10, 16, v10
    v_mul_u32_u24 v11, 24, v10
    v_sub_u32 v11, v0, v11
    v_mul_u32_u24 v124, 576, v10
    v_lshl_add_u32 v124, v11, 1, v124
    v_mul_u32_u24 v127, 48, v10
    v_lshlrev_b32 v126, 2, v11
    global_load_ushort v80, v124, s[6:7] offset:0
    global_load_ushort v81, v124, s[6:7] offset:48
    global_load_ushort v82, v124, s[6:7] offset:96
    global_load_ushort v83, v124, s[6:7] offset:144
    global_load_ushort v84, v124, s[6:7] offset:192
    global_load_ushort v85, v124, s[6:7] offset:240
    global_load_ushort v86, v124, s[6:7] offset:288
    global_load_ushort v87, v124, s[6:7] offset:336
    global_load_ushort v88, v124, s[6:7] offset:384
    global_load_ushort v89, v124, s[6:7] offset:432
    global_load_ushort v90, v124, s[6:7] offset:480
    global_load_ushort v91, v124, s[6:7] offset:528
    v_subrev_u32 v125, 384, v0
    v_cmp_gt_u32 vcc, 384, v0
    s_nop 1
    v_cndmask_b32 v125, v125, v0, vcc
    v_lshlrev_b32 v125, 1, v125
    global_load_ushort v92, v125, s[8:9] offset:0
    global_load_ushort v93, v125, s[8:9] offset:768
    global_load_ushort v94, v125, s[8:9] offset:1536
    global_load_ushort v95, v125, s[8:9] offset:2304
    global_load_ushort v96, v125, s[8:9] offset:3072
    v_add_u32 v125, 3840, v125
    global_load_ushort v97, v125, s[8:9] offset:0
    global_load_ushort v98, v125, s[8:9] offset:768
    global_load_ushort v99, v125, s[8:9] offset:1536
    global_load_ushort v100, v125, s[8:9] offset:2304
    global_load_ushort v101, v125, s[8:9] offset:3072
    v_add_u32 v125, 3840, v125
    global_load_ushort v102, v125, s[8:9] offset:0
    global_load_ushort v103, v125, s[8:9] offset:768
    global_load_ushort v104, v125, s[8:9] offset:1536
    global_load_ushort v105, v125, s[8:9] offset:2304
    global_load_ushort v106, v125, s[8:9] offset:3072
    v_add_u32 v125, 3840, v125
    global_load_ushort v107, v125, s[8:9] offset:0
    global_load_ushort v108, v125, s[8:9] offset:768
    global_load_ushort v109, v125, s[8:9] offset:1536
    global_load_ushort v110, v125, s[8:9] offset:2304
    global_load_ushort v111, v125, s[8:9] offset:3072
    v_add_u32 v125, 3840, v125
    global_load_ushort v112, v125, s[8:9] offset:0
    global_load_ushort v113, v125, s[8:9] offset:768
    global_load_ushort v114, v125, s[8:9] offset:1536
    global_load_ushort v115, v125, s[8:9] offset:2304
    v_and_b32 v10, 31, v0
    v_lshlrev_b32 v10, 2, v10
    v_mov_b32 v11, 0
    ds_write_b32 v10, v11 offset:26112
    v_mov_b32 v2, 0
    v_mov_b32 v3, 0
    v_mov_b32 v4, 0
    v_mov_b32 v5, 0
    v_mov_b32 v6, 0
    v_mov_b32 v7, 0
    v_mov_b32 v8, 0
    v_mov_b32 v9, 0
    s_waitcnt vmcnt(51)
    s_memtime s[66:67]
    v_lshlrev_b32 v10, 16, v16
    v_and_b32 v11, 0xffff0000, v16
    v_add_f32 v2, v2, v10
    v_add_f32 v3, v3, v11
    v_lshlrev_b32 v10, 16, v17
    v_and_b32 v11, 0xffff0000, v17
    v_add_f32 v4, v4, v10
    v_add_f32 v5, v5, v11
    v_lshlrev_b32 v10, 16, v18
    v_and_b32 v11, 0xffff0000, v18
    v_add_f32 v6, v6, v10
    v_add_f32 v7, v7, v11
    v_lshlrev_b32 v10, 16, v19
    v_and_b32 v11, 0xffff0000, v19
    v_add_f32 v8, v8, v10
    v_add_f32 v9, v9, v11
    s_waitcnt vmcnt(50)
    v_lshlrev_b32 v10, 16, v20
    v_and_b32 v11, 0xffff0000, v20
    v_add_f32 v2, v2, v10
    v_add_f32 v3, v3, v11
    v_lshlrev_b32 v10, 16, v21
    v_and_b32 v11, 0xffff0000, v21
    v_add_f32 v4, v4, v10
    v_add_f32 v5, v5, v11
    v_lshlrev_b32 v10, 16, v22
    v_and_b32 v11, 0xffff0000, v22
    v_add_f32 v6, v6, v10
    v_add_f32 v7, v7, v11
    v_lshlrev_b32 v10, 16, v23
    v_and_b32 v11, 0xffff0000, v23
    v_add_f32 v8, v8, v10
    v_add_f32 v9, v9, v11
    s_waitcnt vmcnt(49)
    v_lshlrev_b32 v10, 16, v24
    v_and_b32 v11, 0xffff0000, v24
    v_add_f32 v2, v2, v10
    v_add_f32 v3, v3, v11
    v_lshlrev_b32 v10, 16, v25
    v_and_b32 v11, 0xffff0000, v25
    v_add_f32 v4, v4, v10
    v_add_f32 v5, v5, v11
    v_lshlrev_b32 v10, 16, v26
    v_and_b32 v11, 0xffff0000, v26
    v_add_f32 v6, v6, v10
    v_add_f32 v7, v7, v11
    v_lshlrev_b32 v10, 16, v27
    v_and_b32 v11, 0xffff0000, v27
    v_add_f32 v8, v8, v10
    v_add_f32 v9, v9, v11
    s_waitcnt vmcnt(48)
    v_lshlrev_b32 v10, 16, v28
    v_and_b32 v11, 0xffff0000, v28
    v_add_f32 v2, v2, v10
    v_add_f32 v3, v3, v11
    v_lshlrev_b32 v10, 16, v29
    v_and_b32 v11, 0xffff0000, v29
    v_add_f32 v4, v4, v10
    v_add_f32 v5, v5, v11
    v_lshlrev_b32 v10, 16, v30
    v_and_b32 v11, 0xffff0000, v30
    v_add_f32 v6, v6, v10
    v_add_f32 v7, v7, v11
    v_lshlrev_b32 v10, 16, v31
    v_and_b32 v11, 0xffff0000, v31
    v_add_f32 v8, v8, v10
    v_add_f32 v9, v9, v11
    s_waitcnt vmcnt(47)
    v_lshlrev_b32 v10, 16, v32
    v_and_b32 v11, 0xffff0000, v32
    v_add_f32 v2, v2, v10
    v_add_f32 v3, v3, v11
    v_lshlrev_b32 v10, 16, v33
    v_and_b32 v11, 0xffff0000, v33
    v_add_f32 v4, v4, v10
    v_add_f32 v5, v5, v11
    v_lshlrev_b32 v10, 16, v34
    v_and_b32 v11, 0xffff0000, v34
    v_add_f32 v6, v6, v10
    v_add_f32 v7, v7, v11
    v_lshlrev_b32 v10, 16, v35
    v_and_b32 v11, 0xffff0000, v35
    v_add_f32 v8, v8, v10
    v_add_f32 v9, v9, v11
    s_waitcnt vmcnt(46)
    v_lshlrev_b32 v10, 16, v36
    v_and_b32 v11, 0xffff0000, v36
    v_add_f32 v2, v2, v10
    v_add_f32 v3, v3, v11
    v_lshlrev_b32 v10, 16, v37
    v_and_b32 v11, 0xffff0000, v37
    v_add_f32 v4, v4, v10
    v_add_f32 v5, v5, v11
    v_lshlrev_b32 v10, 16, v38
    v_and_b32 v11, 0xffff0000, v38
    v_add_f32 v6, v6, v10
    v_add_f32 v7, v7, v11
    v_lshlrev_b32 v10, 16, v39
    v_and_b32 v11, 0xffff0000, v39
    v_add_f32 v8, v8, v10
    v_add_f32 v9, v9, v11
    s_waitcnt vmcnt(45)
    v_lshlrev_b32 v10, 16, v40
    v_and_b32 v11, 0xffff0000, v40
    v_add_f32 v2, v2, v10
    v_add_f32 v3, v3, v11
    v_lshlrev_b32 v10, 16, v41
    v_and_b32 v11, 0xffff0000, v41
    v_add_f32 v4, v4, v10
    v_add_f32 v5, v5, v11
    v_lshlrev_b32 v10, 16, v42
    v_and_b32 v11, 0xffff0000, v42
    v_add_f32 v6, v6, v10
    v_add_f32 v7, v7, v11
    v_lshlrev_b32 v10, 16, v43
    v_and_b32 v11, 0xffff0000, v43
    v_add_f32 v8, v8, v10
    v_add_f32 v9, v9, v11
    s_waitcnt vmcnt(44)
    s_memtime s[68:69]
    v_lshlrev_b32 v10, 16, v44
    v_and_b32 v11, 0xffff0000, v44
    v_add_f32 v2, v2, v10
    v_add_f32 v3, v3, v11
    v_lshlrev_b32 v10, 16, v45
    v_and_b32 v11, 0xffff0000, v45
    v_add_f32 v4, v4, v10
    v_add_f32 v5, v5, v11
    v_lshlrev_b32 v10, 16, v46
    v_and_b32 v11, 0xffff0000, v46
    v_add_f32 v6, v6, v10
    v_add_f32 v7, v7, v11
    v_lshlrev_b32 v10, 16, v47
    v_and_b32 v11, 0xffff0000, v47
    v_add_f32 v8, v8, v10
    v_add_f32 v9, v9, v11
    s_waitcnt vmcnt(43)
    v_lshlrev_b32 v10, 16, v48
    v_and_b32 v11, 0xffff0000, v48
    v_add_f32 v2, v2, v10
    v_add_f32 v3, v3, v11
    v_lshlrev_b32 v10, 16, v49
    v_and_b32 v11, 0xffff0000, v49
    v_add_f32 v4, v4, v10
    v_add_f32 v5, v5, v11
    v_lshlrev_b32 v10, 16, v50
    v_and_b32 v11, 0xffff0000, v50
    v_add_f32 v6, v6, v10
    v_add_f32 v7, v7, v11
    v_lshlrev_b32 v10, 16, v51
    v_and_b32 v11, 0xffff0000, v51
    v_add_f32 v8, v8, v10
    v_add_f32 v9, v9, v11
    s_waitcnt vmcnt(42)
    v_lshlrev_b32 v10, 16, v52
    v_and_b32 v11, 0xffff0000, v52
    v_add_f32 v2, v2, v10
    v_add_f32 v3, v3, v11
    v_lshlrev_b32 v10, 16, v53
    v_and_b32 v11, 0xffff0000, v53
    v_add_f32 v4, v4, v10
    v_add_f32 v5, v5, v11
    v_lshlrev_b32 v10, 16, v54
    v_and_b32 v11, 0xffff0000, v54
    v_add_f32 v6, v6, v10
    v_add_f32 v7, v7, v11
    v_lshlrev_b32 v10, 16, v55
    v_and_b32 v11, 0xffff0000, v55
    v_add_f32 v8, v8, v10
    v_add_f32 v9, v9, v11
    s_waitcnt vmcnt(41)
    v_lshlrev_b32 v10, 16, v56
    v_and_b32 v11, 0xffff0000, v56
    v_add_f32 v2, v2, v10
    v_add_f32 v3, v3, v11
    v_lshlrev_b32 v10, 16, v57
    v_and_b32 v11, 0xffff0000, v57
    v_add_f32 v4, v4, v10
    v_add_f32 v5, v5, v11
    v_lshlrev_b32 v10, 16, v58
    v_and_b32 v11, 0xffff0000, v58
    v_add_f32 v6, v6, v10
    v_add_f32 v7, v7, v11
    v_lshlrev_b32 v10, 16, v59
    v_and_b32 v11, 0xffff0000, v59
    v_add_f32 v8, v8, v10
    v_add_f32 v9, v9, v11
    s_waitcnt vmcnt(40)
    v_lshlrev_b32 v10, 16, v60
    v_and_b32 v11, 0xffff0000, v60
    v_add_f32 v2, v2, v10
    v_add_f32 v3, v3, v11
    v_lshlrev_b32 v10, 16, v61
    v_and_b32 v11, 0xffff0000, v61
    v_add_f32 v4, v4, v10
    v_add_f32 v5, v5, v11
    v_lshlrev_b32 v10, 16, v62
    v_and_b32 v11, 0xffff0000, v62
    v_add_f32 v6, v6, v10
    v_add_f32 v7, v7, v11
    v_lshlrev_b32 v10, 16, v63
    v_and_b32 v11, 0xffff0000, v63
    v_add_f32 v8, v8, v10
    v_add_f32 v9, v9, v11
    s_waitcnt vmcnt(39)
    v_lshlrev_b32 v10, 16, v64
    v_and_b32 v11, 0xffff0000, v64
    v_add_f32 v2, v2, v10
    v_add_f32 v3, v3, v11
    v_lshlrev_b32 v10, 16, v65
    v_and_b32 v11, 0xffff0000, v65
    v_add_f32 v4, v4, v10
    v_add_f32 v5, v5, v11
    v_lshlrev_b32 v10, 16, v66
    v_and_b32 v11, 0xffff0000, v66
    v_add_f32 v6, v6, v10
    v_add_f32 v7, v7, v11
    v_lshlrev_b32 v10, 16, v67
    v_and_b32 v11, 0xffff0000, v67
    v_add_f32 v8, v8, v10
    v_add_f32 v9, v9, v11
    s_waitcnt vmcnt(38)
    v_lshlrev_b32 v10, 16, v68
    v_and_b32 v11, 0xffff0000, v68
    v_add_f32 v2, v2, v10
    v_add_f32 v3, v3, v11
    v_lshlrev_b32 v10, 16, v69
    v_and_b32 v11, 0xffff0000, v69
    v_add_f32 v4, v4, v10
    v_add_f32 v5, v5, v11
    v_lshlrev_b32 v10, 16, v70
    v_and_b32 v11, 0xffff0000, v70
    v_add_f32 v6, v6, v10
    v_add_f32 v7, v7, v11
    v_lshlrev_b32 v10, 16, v71
    v_and_b32 v11, 0xffff0000, v71
    v_add_f32 v8, v8, v10
    v_add_f32 v9, v9, v11
    s_waitcnt vmcnt(37)
    v_lshlrev_b32 v10, 16, v72
    v_and_b32 v11, 0xffff0000, v72
    v_add_f32 v2, v2, v10
    v_add_f32 v3, v3, v11
    v_lshlrev_b32 v10, 16, v73
    v_and_b32 v11, 0xffff0000, v73
    v_add_f32 v4, v4, v10
    v_add_f32 v5, v5, v11
    v_lshlrev_b32 v10, 16, v74
    v_and_b32 v11, 0xffff0000, v74
    v_add_f32 v6, v6, v10
    v_add_f32 v7, v7, v11
    v_lshlrev_b32 v10, 16, v75
    v_and_b32 v11, 0xffff0000, v75
    v_add_f32 v8, v8, v10
    v_add_f32 v9, v9, v11
    s_waitcnt vmcnt(36)
    v_lshlrev_b32 v10, 16, v76
    v_and_b32 v11, 0xffff0000, v76
    v_add_f32 v2, v2, v10
    v_add_f32 v3, v3, v11
    v_lshlrev_b32 v10, 16, v77
    v_and_b32 v11, 0xffff0000, v77
    v_add_f32 v4, v4, v10
    v_add_f32 v5, v5, v11
    v_lshlrev_b32 v10, 16, v78
    v_and_b32 v11, 0xffff0000, v78
    v_add_f32 v6, v6, v10
    v_add_f32 v7, v7, v11
    v_lshlrev_b32 v10, 16, v79
    v_and_b32 v11, 0xffff0000, v79
    v_add_f32 v8, v8, v10
    v_add_f32 v9, v9, v11
    v_lshlrev_b32 v10, 5, v0
    ds_write_b128 v10, v[2:5] offset:0
    ds_write_b128 v10, v[6:9] offset:16
    s_cmp_lg_u32 s20, 0
    s_cbranch_scc1 L_flag_ok
    v_mov_b32 v14, 0
L_flag:
    global_load_dword v10, v14, s[12:13] sc1
    s_waitcnt vmcnt(0)
    v_readfirstlane_b32 s22, v10
    s_cmp_lg_u32 s22, 0
    s_cbranch_scc1 L_flag_ok
    s_sleep 1
    s_add_u32 s21, s21, 1
    s_cmp_lt_u32 s21, 200000
    s_cbranch_scc1 L_flag
L_flag_ok:
    s_waitcnt lgkmcnt(0)
    s_memtime s[70:71]
    s_barrier
    s_cmp_ge_u32 s20, 6
    s_cbranch_scc1 L_skip_atomic
    v_lshlrev_b32 v14, 2, v0
    ds_read_b32 v116, v14 offset:0
    ds_read_b32 v117, v14 offset:1536
    ds_read_b32 v118, v14 offset:3072
    ds_read_b32 v119, v14 offset:4608
    ds_read_b32 v120, v14 offset:6144
    ds_read_b32 v121, v14 offset:7680
    ds_read_b32 v122, v14 offset:9216
    ds_read_b32 v123, v14 offset:10752
    ds_read_b32 v10, v14 offset:12288
    ds_read_b32 v11, v14 offset:13824
    ds_read_b32 v12, v14 offset:15360
    ds_read_b32 v13, v14 offset:16896
    ds_read_b32 v2, v14 offset:18432
    ds_read_b32 v3, v14 offset:19968
    ds_read_b32 v4, v14 offset:21504
    ds_read_b32 v5, v14 offset:23040
    s_waitcnt lgkmcnt(0)
    v_add_f32 v116, v116, v117
    v_add_f32 v118, v118, v119
    v_add_f32 v120, v120, v121
    v_add_f32 v122, v122, v123
    v_add_f32 v10, v10, v11
    v_add_f32 v12, v12, v13
    v_add_f32 v2, v2, v3
    v_add_f32 v4, v4, v5
    v_add_f32 v116, v116, v118
    v_add_f32 v120, v120, v122
    v_add_f32 v10, v10, v12
    v_add_f32 v2, v2, v4
    v_add_f32 v116, v116, v120
    v_add_f32 v10, v10, v2
    v_add_f32 v116, v116, v10
    global_atomic_add_f32 v14, v116, s[24:25]
    s_waitcnt vmcnt(0)
L_skip_atomic:
    s_barrier
    s_memtime s[72:73]
    s_cmp_lg_u32 s20, 0
    s_cbranch_scc1 L_arrived
    v_mov_b32 v14, 0
    v_mov_b32 v10, 1
    s_mov_b64 s[28:29], exec
    s_mov_b64 exec, 1
    global_atomic_add v14, v10, s[12:13] offset:128
    s_mov_b64 exec, s[28:29]
L_poll:
    global_load_dword v10, v14, s[12:13] offset:128 sc1
    s_waitcnt vmcnt(0)
    v_readfirstlane_b32 s22, v10
    s_cmp_ge_u32 s22, 256
    s_cbranch_scc1 L_arrived
    s_sleep 1
    s_add_u32 s21, s21, 1
    s_cmp_lt_u32 s21, 200000
    s_cbranch_scc1 L_poll
L_arrived:
    s_barrier
    s_memtime s[74:75]
    s_cmp_ge_u32 s20, 6
    s_cbranch_scc1 L_skip_mean
    v_lshlrev_b32 v14, 2, v0
    global_load_dword v116, v14, s[14:15] offset:0 sc1
    global_load_dword v117, v14, s[14:15] offset:1536 sc1
    v_add_u32 v14, 3072, v14
    global_load_dword v118, v14, s[14:15] offset:0 sc1
    global_load_dword v119, v14, s[14:15] offset:1536 sc1
    v_add_u32 v14, 3072, v14
    global_load_dword v120, v14, s[14:15] offset:0 sc1
    global_load_dword v121, v14, s[14:15] offset:1536 sc1
    v_add_u32 v14, 3072, v14
    global_load_dword v122, v14, s[14:15] offset:0 sc1
    global_load_dword v123, v14, s[14:15] offset:1536 sc1
    s_waitcnt vmcnt(0)
    v_add_f32 v116, v116, v117
    v_add_f32 v118, v118, v119
    v_add_f32 v120, v120, v121
    v_add_f32 v122, v122, v123
    v_add_f32 v116, v116, v118
    v_add_f32 v120, v120, v122
    v_add_f32 v116, v116, v120
    v_mul_f32 v10, 0x37800000, v116
    v_cvt_pk_bf16_f32 v10, v10, v10
    v_lshlrev_b32 v10, 16, v10
    v_lshlrev_b32 v14, 2, v0
    ds_write_b32 v14, v10 offset:24576
    s_waitcnt lgkmcnt(0)
L_skip_mean:
    s_barrier
    ds_read_b128 v[116:119], v127 offset:24576
    ds_read_b128 v[120:123], v127 offset:24592
    ds_read_b128 v[10:13], v127 offset:24608
    v_lshlrev_b32 v80, 16, v80
    v_lshlrev_b32 v81, 16, v81
    v_lshlrev_b32 v82, 16, v82
    v_lshlrev_b32 v83, 16, v83
    v_lshlrev_b32 v84, 16, v84
    v_lshlrev_b32 v85, 16, v85
    v_lshlrev_b32 v86, 16, v86
    v_lshlrev_b32 v87, 16, v87
    v_lshlrev_b32 v88, 16, v88
    v_lshlrev_b32 v89, 16, v89
    v_lshlrev_b32 v90, 16, v90
    v_lshlrev_b32 v91, 16, v91
    v_lshlrev_b32 v92, 16, v92
    v_lshlrev_b32 v93, 16, v93
    v_lshlrev_b32 v94, 16, v94
    v_lshlrev_b32 v95, 16, v95
    v_lshlrev_b32 v96, 16, v96
    v_lshlrev_b32 v97, 16, v97
    v_lshlrev_b32 v98, 16, v98
    v_lshlrev_b32 v99, 16, v99
    v_lshlrev_b32 v100, 16, v100
    v_lshlrev_b32 v101, 16, v101
    v_lshlrev_b32 v102, 16, v102
    v_lshlrev_b32 v103, 16, v103
    v_lshlrev_b32 v104, 16, v104
    v_lshlrev_b32 v105, 16, v105
    v_lshlrev_b32 v106, 16, v106
    v_lshlrev_b32 v107, 16, v107
    v_lshlrev_b32 v108, 16, v108
    v_lshlrev_b32 v109, 16, v109
    v_lshlrev_b32 v110, 16, v110
    v_lshlrev_b32 v111, 16, v111
    v_lshlrev_b32 v112, 16, v112
    v_lshlrev_b32 v113, 16, v113
    v_lshlrev_b32 v114, 16, v114
    v_lshlrev_b32 v115, 16, v115
    s_waitcnt lgkmcnt(0)
    v_mul_f32 v14, v116, v80
    v_fmac_f32 v14, v117, v81
    v_fmac_f32 v14, v118, v82
    v_fmac_f32 v14, v119, v83
    v_fmac_f32 v14, v120, v84
    v_fmac_f32 v14, v121, v85
    v_fmac_f32 v14, v122, v86
    v_fmac_f32 v14, v123, v87
    v_fmac_f32 v14, v10, v88
    v_fmac_f32 v14, v11, v89
    v_fmac_f32 v14, v12, v90
    v_fmac_f32 v14, v13, v91
    ds_add_f32 v126, v14 offset:26112
    s_waitcnt lgkmcnt(0)
    s_barrier
    v_and_b32 v10, 31, v0
    v_lshlrev_b32 v10, 2, v10
    ds_read_b32 v10, v10 offset:26112
    s_waitcnt lgkmcnt(0)
    v_cvt_pk_bf16_f32 v10, v10, v10
    v_lshlrev_b32 v10, 16, v10
    v_mul_f32 v11, 0xbfb8aa3b, v10
    v_exp_f32 v11, v11
    s_nop 0
    v_add_f32 v11, 1.0, v11
    v_rcp_f32 v11, v11
    s_nop 0
    v_mul_f32 v10, v10, v11
    v_cvt_pk_bf16_f32 v10, v10, v10
    v_lshlrev_b32 v10, 16, v10
    s_nop 0
    v_readlane_b32 s40, v10, 0
    v_readlane_b32 s41, v10, 1
    v_readlane_b32 s42, v10, 2
    v_readlane_b32 s43, v10, 3
    v_readlane_b32 s44, v10, 4
    v_readlane_b32 s45, v10, 5
    v_readlane_b32 s46, v10, 6
    v_readlane_b32 s47, v10, 7
    v_readlane_b32 s48, v10, 8
    v_readlane_b32 s49, v10, 9
    v_readlane_b32 s50, v10, 10
    v_readlane_b32 s51, v10, 11
    v_readlane_b32 s52, v10, 12
    v_readlane_b32 s53, v10, 13
    v_readlane_b32 s54, v10, 14
    v_readlane_b32 s55, v10, 15
    v_readlane_b32 s56, v10, 16
    v_readlane_b32 s57, v10, 17
    v_readlane_b32 s58, v10, 18
    v_readlane_b32 s59, v10, 19
    v_readlane_b32 s60, v10, 20
    v_readlane_b32 s61, v10, 21
    v_readlane_b32 s62, v10, 22
    v_readlane_b32 s63, v10, 23
    s_nop 1
    v_mul_f32 v14, s40, v92
    v_fmac_f32 v14, s41, v93
    v_fmac_f32 v14, s42, v94
    v_fmac_f32 v14, s43, v95
    v_fmac_f32 v14, s44, v96
    v_fmac_f32 v14, s45, v97
    v_fmac_f32 v14, s46, v98
    v_fmac_f32 v14, s47, v99
    v_fmac_f32 v14, s48, v100
    v_fmac_f32 v14, s49, v101
    v_fmac_f32 v14, s50, v102
    v_fmac_f32 v14, s51, v103
    v_fmac_f32 v14, s52, v104
    v_fmac_f32 v14, s53, v105
    v_fmac_f32 v14, s54, v106
    v_fmac_f32 v14, s55, v107
    v_fmac_f32 v14, s56, v108
    v_fmac_f32 v14, s57, v109
    v_fmac_f32 v14, s58, v110
    v_fmac_f32 v14, s59, v111
    v_fmac_f32 v14, s60, v112
    v_fmac_f32 v14, s61, v113
    v_fmac_f32 v14, s62, v114
    v_fmac_f32 v14, s63, v115
    v_cvt_pk_bf16_f32 v14, v14, v14
    v_lshlrev_b32 v14, 16, v14
    v_mul_f32 v11, 0xbfb8aa3b, v14
    v_exp_f32 v11, v11
    s_nop 0
    v_add_f32 v11, 1.0, v11
    v_rcp_f32 v11, v11
    s_nop 0
    v_cvt_pk_bf16_f32 v11, v11, v11
    v_lshlrev_b32 v11, 16, v11
    v_subrev_u32 v10, 384, v0
    v_cmp_gt_u32 vcc, 384, v0
    s_nop 1
    v_cndmask_b32 v10, v10, v0, vcc
    v_lshlrev_b32 v10, 2, v10
    ds_write_b32 v10, v11 offset:26240
    s_waitcnt lgkmcnt(0)
    s_barrier
    s_memtime s[76:77]
    v_mul_u32_u24 v10, 1366, v0
    v_lshrrev_b32 v10, 16, v10
    v_mul_u32_u24 v10, 48, v10
    v_sub_u32 v10, v0, v10
    v_lshlrev_b32 v10, 5, v10
    ds_read_b128 v[116:119], v10 offset:26240
    ds_read_b128 v[120:123], v10 offset:26256
    s_waitcnt lgkmcnt(0)
    v_lshlrev_b32 v10, 16, v16
    v_and_b32 v11, 0xffff0000, v16
    v_mul_f32 v10, v10, v116
    v_mul_f32 v11, v11, v117
    v_cvt_pk_bf16_f32 v16, v10, v11
    v_lshlrev_b32 v10, 16, v17
    v_and_b32 v11, 0xffff0000, v17
    v_mul_f32 v10, v10, v118
    v_mul_f32 v11, v11, v119
    v_cvt_pk_bf16_f32 v17, v10, v11
    v_lshlrev_b32 v10, 16, v18
    v_and_b32 v11, 0xffff0000, v18
    v_mul_f32 v10, v10, v120
    v_mul_f32 v11, v11, v121
    v_cvt_pk_bf16_f32 v18, v10, v11
    v_lshlrev_b32 v10, 16, v19
    v_and_b32 v11, 0xffff0000, v19
    v_mul_f32 v10, v10, v122
    v_mul_f32 v11, v11, v123
    v_cvt_pk_bf16_f32 v19, v10, v11
    global_store_dwordx4 v1, v[16:19], s[18:19]
    s_add_u32 s18, s18, 12288
    s_addc_u32 s19, s19, 0
    v_lshlrev_b32 v10, 16, v20
    v_and_b32 v11, 0xffff0000, v20
    v_mul_f32 v10, v10, v116
    v_mul_f32 v11, v11, v117
    v_cvt_pk_bf16_f32 v20, v10, v11
    v_lshlrev_b32 v10, 16, v21
    v_and_b32 v11, 0xffff0000, v21
    v_mul_f32 v10, v10, v118
    v_mul_f32 v11, v11, v119
    v_cvt_pk_bf16_f32 v21, v10, v11
    v_lshlrev_b32 v10, 16, v22
    v_and_b32 v11, 0xffff0000, v22
    v_mul_f32 v10, v10, v120
    v_mul_f32 v11, v11, v121
    v_cvt_pk_bf16_f32 v22, v10, v11
    v_lshlrev_b32 v10, 16, v23
    v_and_b32 v11, 0xffff0000, v23
    v_mul_f32 v10, v10, v122
    v_mul_f32 v11, v11, v123
    v_cvt_pk_bf16_f32 v23, v10, v11
    global_store_dwordx4 v1, v[20:23], s[18:19]
    s_add_u32 s18, s18, 12288
    s_addc_u32 s19, s19, 0
    v_lshlrev_b32 v10, 16, v24
    v_and_b32 v11, 0xffff0000, v24
    v_mul_f32 v10, v10, v116
    v_mul_f32 v11, v11, v117
    v_cvt_pk_bf16_f32 v24, v10, v11
    v_lshlrev_b32 v10, 16, v25
    v_and_b32 v11, 0xffff0000, v25
    v_mul_f32 v10, v10, v118
    v_mul_f32 v11, v11, v119
    v_cvt_pk_bf16_f32 v25, v10, v11
    v_lshlrev_b32 v10, 16, v26
    v_and_b32 v11, 0xffff0000, v26
    v_mul_f32 v10, v10, v120
    v_mul_f32 v11, v11, v121
    v_cvt_pk_bf16_f32 v26, v10, v11
    v_lshlrev_b32 v10, 16, v27
    v_and_b32 v11, 0xffff0000, v27
    v_mul_f32 v10, v10, v122
    v_mul_f32 v11, v11, v123
    v_cvt_pk_bf16_f32 v27, v10, v11
    global_store_dwordx4 v1, v[24:27], s[18:19]
    s_add_u32 s18, s18, 12288
    s_addc_u32 s19, s19, 0
    v_lshlrev_b32 v10, 16, v28
    v_and_b32 v11, 0xffff0000, v28
    v_mul_f32 v10, v10, v116
    v_mul_f32 v11, v11, v117
    v_cvt_pk_bf16_f32 v28, v10, v11
    v_lshlrev_b32 v10, 16, v29
    v_and_b32 v11, 0xffff0000, v29
    v_mul_f32 v10, v10, v118
    v_mul_f32 v11, v11, v119
    v_cvt_pk_bf16_f32 v29, v10, v11
    v_lshlrev_b32 v10, 16, v30
    v_and_b32 v11, 0xffff0000, v30
    v_mul_f32 v10, v10, v120
    v_mul_f32 v11, v11, v121
    v_cvt_pk_bf16_f32 v30, v10, v11
    v_lshlrev_b32 v10, 16, v31
    v_and_b32 v11, 0xffff0000, v31
    v_mul_f32 v10, v10, v122
    v_mul_f32 v11, v11, v123
    v_cvt_pk_bf16_f32 v31, v10, v11
    global_store_dwordx4 v1, v[28:31], s[18:19]
    s_add_u32 s18, s18, 12288
    s_addc_u32 s19, s19, 0
    v_lshlrev_b32 v10, 16, v32
    v_and_b32 v11, 0xffff0000, v32
    v_mul_f32 v10, v10, v116
    v_mul_f32 v11, v11, v117
    v_cvt_pk_bf16_f32 v32, v10, v11
    v_lshlrev_b32 v10, 16, v33
    v_and_b32 v11, 0xffff0000, v33
    v_mul_f32 v10, v10, v118
    v_mul_f32 v11, v11, v119
    v_cvt_pk_bf16_f32 v33, v10, v11
    v_lshlrev_b32 v10, 16, v34
    v_and_b32 v11, 0xffff0000, v34
    v_mul_f32 v10, v10, v120
    v_mul_f32 v11, v11, v121
    v_cvt_pk_bf16_f32 v34, v10, v11
    v_lshlrev_b32 v10, 16, v35
    v_and_b32 v11, 0xffff0000, v35
    v_mul_f32 v10, v10, v122
    v_mul_f32 v11, v11, v123
    v_cvt_pk_bf16_f32 v35, v10, v11
    global_store_dwordx4 v1, v[32:35], s[18:19]
    s_add_u32 s18, s18, 12288
    s_addc_u32 s19, s19, 0
    v_lshlrev_b32 v10, 16, v36
    v_and_b32 v11, 0xffff0000, v36
    v_mul_f32 v10, v10, v116
    v_mul_f32 v11, v11, v117
    v_cvt_pk_bf16_f32 v36, v10, v11
    v_lshlrev_b32 v10, 16, v37
    v_and_b32 v11, 0xffff0000, v37
    v_mul_f32 v10, v10, v118
    v_mul_f32 v11, v11, v119
    v_cvt_pk_bf16_f32 v37, v10, v11
    v_lshlrev_b32 v10, 16, v38
    v_and_b32 v11, 0xffff0000, v38
    v_mul_f32 v10, v10, v120
    v_mul_f32 v11, v11, v121
    v_cvt_pk_bf16_f32 v38, v10, v11
    v_lshlrev_b32 v10, 16, v39
    v_and_b32 v11, 0xffff0000, v39
    v_mul_f32 v10, v10, v122
    v_mul_f32 v11, v11, v123
    v_cvt_pk_bf16_f32 v39, v10, v11
    global_store_dwordx4 v1, v[36:39], s[18:19]
    s_add_u32 s18, s18, 12288
    s_addc_u32 s19, s19, 0
    v_lshlrev_b32 v10, 16, v40
    v_and_b32 v11, 0xffff0000, v40
    v_mul_f32 v10, v10, v116
    v_mul_f32 v11, v11, v117
    v_cvt_pk_bf16_f32 v40, v10, v11
    v_lshlrev_b32 v10, 16, v41
    v_and_b32 v11, 0xffff0000, v41
    v_mul_f32 v10, v10, v118
    v_mul_f32 v11, v11, v119
    v_cvt_pk_bf16_f32 v41, v10, v11
    v_lshlrev_b32 v10, 16, v42
    v_and_b32 v11, 0xffff0000, v42
    v_mul_f32 v10, v10, v120
    v_mul_f32 v11, v11, v121
    v_cvt_pk_bf16_f32 v42, v10, v11
    v_lshlrev_b32 v10, 16, v43
    v_and_b32 v11, 0xffff0000, v43
    v_mul_f32 v10, v10, v122
    v_mul_f32 v11, v11, v123
    v_cvt_pk_bf16_f32 v43, v10, v11
    global_store_dwordx4 v1, v[40:43], s[18:19]
    s_add_u32 s18, s18, 12288
    s_addc_u32 s19, s19, 0
    v_lshlrev_b32 v10, 16, v44
    v_and_b32 v11, 0xffff0000, v44
    v_mul_f32 v10, v10, v116
    v_mul_f32 v11, v11, v117
    v_cvt_pk_bf16_f32 v44, v10, v11
    v_lshlrev_b32 v10, 16, v45
    v_and_b32 v11, 0xffff0000, v45
    v_mul_f32 v10, v10, v118
    v_mul_f32 v11, v11, v119
    v_cvt_pk_bf16_f32 v45, v10, v11
    v_lshlrev_b32 v10, 16, v46
    v_and_b32 v11, 0xffff0000, v46
    v_mul_f32 v10, v10, v120
    v_mul_f32 v11, v11, v121
    v_cvt_pk_bf16_f32 v46, v10, v11
    v_lshlrev_b32 v10, 16, v47
    v_and_b32 v11, 0xffff0000, v47
    v_mul_f32 v10, v10, v122
    v_mul_f32 v11, v11, v123
    v_cvt_pk_bf16_f32 v47, v10, v11
    global_store_dwordx4 v1, v[44:47], s[18:19]
    s_add_u32 s18, s18, 12288
    s_addc_u32 s19, s19, 0
    v_lshlrev_b32 v10, 16, v48
    v_and_b32 v11, 0xffff0000, v48
    v_mul_f32 v10, v10, v116
    v_mul_f32 v11, v11, v117
    v_cvt_pk_bf16_f32 v48, v10, v11
    v_lshlrev_b32 v10, 16, v49
    v_and_b32 v11, 0xffff0000, v49
    v_mul_f32 v10, v10, v118
    v_mul_f32 v11, v11, v119
    v_cvt_pk_bf16_f32 v49, v10, v11
    v_lshlrev_b32 v10, 16, v50
    v_and_b32 v11, 0xffff0000, v50
    v_mul_f32 v10, v10, v120
    v_mul_f32 v11, v11, v121
    v_cvt_pk_bf16_f32 v50, v10, v11
    v_lshlrev_b32 v10, 16, v51
    v_and_b32 v11, 0xffff0000, v51
    v_mul_f32 v10, v10, v122
    v_mul_f32 v11, v11, v123
    v_cvt_pk_bf16_f32 v51, v10, v11
    global_store_dwordx4 v1, v[48:51], s[18:19]
    s_add_u32 s18, s18, 12288
    s_addc_u32 s19, s19, 0
    v_lshlrev_b32 v10, 16, v52
    v_and_b32 v11, 0xffff0000, v52
    v_mul_f32 v10, v10, v116
    v_mul_f32 v11, v11, v117
    v_cvt_pk_bf16_f32 v52, v10, v11
    v_lshlrev_b32 v10, 16, v53
    v_and_b32 v11, 0xffff0000, v53
    v_mul_f32 v10, v10, v118
    v_mul_f32 v11, v11, v119
    v_cvt_pk_bf16_f32 v53, v10, v11
    v_lshlrev_b32 v10, 16, v54
    v_and_b32 v11, 0xffff0000, v54
    v_mul_f32 v10, v10, v120
    v_mul_f32 v11, v11, v121
    v_cvt_pk_bf16_f32 v54, v10, v11
    v_lshlrev_b32 v10, 16, v55
    v_and_b32 v11, 0xffff0000, v55
    v_mul_f32 v10, v10, v122
    v_mul_f32 v11, v11, v123
    v_cvt_pk_bf16_f32 v55, v10, v11
    global_store_dwordx4 v1, v[52:55], s[18:19]
    s_add_u32 s18, s18, 12288
    s_addc_u32 s19, s19, 0
    v_lshlrev_b32 v10, 16, v56
    v_and_b32 v11, 0xffff0000, v56
    v_mul_f32 v10, v10, v116
    v_mul_f32 v11, v11, v117
    v_cvt_pk_bf16_f32 v56, v10, v11
    v_lshlrev_b32 v10, 16, v57
    v_and_b32 v11, 0xffff0000, v57
    v_mul_f32 v10, v10, v118
    v_mul_f32 v11, v11, v119
    v_cvt_pk_bf16_f32 v57, v10, v11
    v_lshlrev_b32 v10, 16, v58
    v_and_b32 v11, 0xffff0000, v58
    v_mul_f32 v10, v10, v120
    v_mul_f32 v11, v11, v121
    v_cvt_pk_bf16_f32 v58, v10, v11
    v_lshlrev_b32 v10, 16, v59
    v_and_b32 v11, 0xffff0000, v59
    v_mul_f32 v10, v10, v122
    v_mul_f32 v11, v11, v123
    v_cvt_pk_bf16_f32 v59, v10, v11
    global_store_dwordx4 v1, v[56:59], s[18:19]
    s_add_u32 s18, s18, 12288
    s_addc_u32 s19, s19, 0
    v_lshlrev_b32 v10, 16, v60
    v_and_b32 v11, 0xffff0000, v60
    v_mul_f32 v10, v10, v116
    v_mul_f32 v11, v11, v117
    v_cvt_pk_bf16_f32 v60, v10, v11
    v_lshlrev_b32 v10, 16, v61
    v_and_b32 v11, 0xffff0000, v61
    v_mul_f32 v10, v10, v118
    v_mul_f32 v11, v11, v119
    v_cvt_pk_bf16_f32 v61, v10, v11
    v_lshlrev_b32 v10, 16, v62
    v_and_b32 v11, 0xffff0000, v62
    v_mul_f32 v10, v10, v120
    v_mul_f32 v11, v11, v121
    v_cvt_pk_bf16_f32 v62, v10, v11
    v_lshlrev_b32 v10, 16, v63
    v_and_b32 v11, 0xffff0000, v63
    v_mul_f32 v10, v10, v122
    v_mul_f32 v11, v11, v123
    v_cvt_pk_bf16_f32 v63, v10, v11
    global_store_dwordx4 v1, v[60:63], s[18:19]
    s_add_u32 s18, s18, 12288
    s_addc_u32 s19, s19, 0
    v_lshlrev_b32 v10, 16, v64
    v_and_b32 v11, 0xffff0000, v64
    v_mul_f32 v10, v10, v116
    v_mul_f32 v11, v11, v117
    v_cvt_pk_bf16_f32 v64, v10, v11
    v_lshlrev_b32 v10, 16, v65
    v_and_b32 v11, 0xffff0000, v65
    v_mul_f32 v10, v10, v118
    v_mul_f32 v11, v11, v119
    v_cvt_pk_bf16_f32 v65, v10, v11
    v_lshlrev_b32 v10, 16, v66
    v_and_b32 v11, 0xffff0000, v66
    v_mul_f32 v10, v10, v120
    v_mul_f32 v11, v11, v121
    v_cvt_pk_bf16_f32 v66, v10, v11
    v_lshlrev_b32 v10, 16, v67
    v_and_b32 v11, 0xffff0000, v67
    v_mul_f32 v10, v10, v122
    v_mul_f32 v11, v11, v123
    v_cvt_pk_bf16_f32 v67, v10, v11
    global_store_dwordx4 v1, v[64:67], s[18:19]
    s_add_u32 s18, s18, 12288
    s_addc_u32 s19, s19, 0
    v_lshlrev_b32 v10, 16, v68
    v_and_b32 v11, 0xffff0000, v68
    v_mul_f32 v10, v10, v116
    v_mul_f32 v11, v11, v117
    v_cvt_pk_bf16_f32 v68, v10, v11
    v_lshlrev_b32 v10, 16, v69
    v_and_b32 v11, 0xffff0000, v69
    v_mul_f32 v10, v10, v118
    v_mul_f32 v11, v11, v119
    v_cvt_pk_bf16_f32 v69, v10, v11
    v_lshlrev_b32 v10, 16, v70
    v_and_b32 v11, 0xffff0000, v70
    v_mul_f32 v10, v10, v120
    v_mul_f32 v11, v11, v121
    v_cvt_pk_bf16_f32 v70, v10, v11
    v_lshlrev_b32 v10, 16, v71
    v_and_b32 v11, 0xffff0000, v71
    v_mul_f32 v10, v10, v122
    v_mul_f32 v11, v11, v123
    v_cvt_pk_bf16_f32 v71, v10, v11
    global_store_dwordx4 v1, v[68:71], s[18:19]
    s_add_u32 s18, s18, 12288
    s_addc_u32 s19, s19, 0
    v_lshlrev_b32 v10, 16, v72
    v_and_b32 v11, 0xffff0000, v72
    v_mul_f32 v10, v10, v116
    v_mul_f32 v11, v11, v117
    v_cvt_pk_bf16_f32 v72, v10, v11
    v_lshlrev_b32 v10, 16, v73
    v_and_b32 v11, 0xffff0000, v73
    v_mul_f32 v10, v10, v118
    v_mul_f32 v11, v11, v119
    v_cvt_pk_bf16_f32 v73, v10, v11
    v_lshlrev_b32 v10, 16, v74
    v_and_b32 v11, 0xffff0000, v74
    v_mul_f32 v10, v10, v120
    v_mul_f32 v11, v11, v121
    v_cvt_pk_bf16_f32 v74, v10, v11
    v_lshlrev_b32 v10, 16, v75
    v_and_b32 v11, 0xffff0000, v75
    v_mul_f32 v10, v10, v122
    v_mul_f32 v11, v11, v123
    v_cvt_pk_bf16_f32 v75, v10, v11
    global_store_dwordx4 v1, v[72:75], s[18:19]
    s_add_u32 s18, s18, 12288
    s_addc_u32 s19, s19, 0
    v_lshlrev_b32 v10, 16, v76
    v_and_b32 v11, 0xffff0000, v76
    v_mul_f32 v10, v10, v116
    v_mul_f32 v11, v11, v117
    v_cvt_pk_bf16_f32 v76, v10, v11
    v_lshlrev_b32 v10, 16, v77
    v_and_b32 v11, 0xffff0000, v77
    v_mul_f32 v10, v10, v118
    v_mul_f32 v11, v11, v119
    v_cvt_pk_bf16_f32 v77, v10, v11
    v_lshlrev_b32 v10, 16, v78
    v_and_b32 v11, 0xffff0000, v78
    v_mul_f32 v10, v10, v120
    v_mul_f32 v11, v11, v121
    v_cvt_pk_bf16_f32 v78, v10, v11
    v_lshlrev_b32 v10, 16, v79
    v_and_b32 v11, 0xffff0000, v79
    v_mul_f32 v10, v10, v122
    v_mul_f32 v11, v11, v123
    v_cvt_pk_bf16_f32 v79, v10, v11
    global_store_dwordx4 v1, v[76:79], s[18:19]
    s_memtime s[78:79]
    s_waitcnt vmcnt(0)
    s_memtime s[80:81]
    s_cmp_lg_u32 s2, 0
    s_cbranch_scc1 L_end
    s_cmp_lg_u32 s20, 0
    s_cbranch_scc1 L_end
    s_waitcnt lgkmcnt(0)
    s_sub_u32 s22, s66, s64
    v_mov_b32 v10, s22
    v_mov_b32 v14, 0
    global_store_dword v14, v10, s[12:13] offset:4
    s_sub_u32 s22, s68, s64
    v_mov_b32 v10, s22
    v_mov_b32 v14, 0
    global_store_dword v14, v10, s[12:13] offset:8
    s_sub_u32 s22, s70, s64
    v_mov_b32 v10, s22
    v_mov_b32 v14, 0
    global_store_dword v14, v10, s[12:13] offset:12
    s_sub_u32 s22, s72, s64
    v_mov_b32 v10, s22
    v_mov_b32 v14, 0
    global_store_dword v14, v10, s[12:13] offset:16
    s_sub_u32 s22, s74, s64
    v_mov_b32 v10, s22
    v_mov_b32 v14, 0
    global_store_dword v14, v10, s[12:13] offset:20
    s_sub_u32 s22, s76, s64
    v_mov_b32 v10, s22
    v_mov_b32 v14, 0
    global_store_dword v14, v10, s[12:13] offset:24
    s_sub_u32 s22, s78, s64
    v_mov_b32 v10, s22
    v_mov_b32 v14, 0
    global_store_dword v14, v10, s[12:13] offset:28
    s_sub_u32 s22, s80, s64
    v_mov_b32 v10, s22
    v_mov_b32 v14, 0
    global_store_dword v14, v10, s[12:13] offset:32
L_end:
    s_endpgm
.section .rodata,"a"
.p2align 6
.amdhsa_kernel standalone__channel_attn_se__vision_kernel
  .amdhsa_next_free_vgpr 128
  .amdhsa_next_free_sgpr 96
  .amdhsa_accum_offset 128
  .amdhsa_group_segment_fixed_size 0
  .amdhsa_kernarg_size 48
  .amdhsa_user_sgpr_count 2
  .amdhsa_user_sgpr_kernarg_segment_ptr 1
  .amdhsa_system_sgpr_workgroup_id_x 1
  .amdhsa_float_denorm_mode_32 3
.end_amdhsa_kernel
```

```asm
; @launch grid=(256,1,1) block=(768,1,1) lds=32768
.amdgcn_target "amdgcn-amd-amdhsa--gfx950"
.text
.globl standalone__channel_attn_se__vision_kernel
.p2align 8
.type standalone__channel_attn_se__vision_kernel,@function
standalone__channel_attn_se__vision_kernel:
    s_cmp_ge_u32 s2, 256
    s_cbranch_scc1 L_end
    s_load_dwordx4 s[4:7], s[0:1], 0
    s_load_dwordx4 s[8:11], s[0:1], 16
    s_load_dwordx4 s[12:15], s[0:1], 32
    v_lshrrev_b32 v10, 6, v0
    v_lshlrev_b32 v1, 4, v0
    v_readfirstlane_b32 s20, v10
    s_mul_i32 s3, s2, 196608
    s_and_b32 s22, s2, 7
    s_mul_i32 s22, s22, 1536
    s_mov_b32 s21, 0
    s_waitcnt lgkmcnt(0)
    s_add_u32 s16, s4, s3
    s_addc_u32 s17, s5, 0
    s_add_u32 s18, s10, s3
    s_addc_u32 s19, s11, 0
    s_add_u32 s24, s14, s22
    s_addc_u32 s25, s15, 0
    s_cmp_lg_u32 s2, 0
    s_cbranch_scc1 L_nozero
    s_cmp_lg_u32 s20, 11
    s_cbranch_scc1 L_nozero
    v_mov_b32 v10, 0
    v_mov_b32 v11, 0
    v_mov_b32 v12, 0
    v_mov_b32 v13, 0
    v_and_b32 v14, 63, v0
    v_lshlrev_b32 v14, 4, v14
    global_store_dwordx4 v14, v[10:13], s[14:15] offset:0 sc1
    global_store_dwordx4 v14, v[10:13], s[14:15] offset:1024 sc1
    global_store_dwordx4 v14, v[10:13], s[14:15] offset:2048 sc1
    global_store_dwordx4 v14, v[10:13], s[14:15] offset:3072 sc1
    v_add_u32 v14, 4096, v14
    global_store_dwordx4 v14, v[10:13], s[14:15] offset:0 sc1
    global_store_dwordx4 v14, v[10:13], s[14:15] offset:1024 sc1
    global_store_dwordx4 v14, v[10:13], s[14:15] offset:2048 sc1
    global_store_dwordx4 v14, v[10:13], s[14:15] offset:3072 sc1
    v_add_u32 v14, 4096, v14
    global_store_dwordx4 v14, v[10:13], s[14:15] offset:0 sc1
    global_store_dwordx4 v14, v[10:13], s[14:15] offset:1024 sc1
    global_store_dwordx4 v14, v[10:13], s[14:15] offset:2048 sc1
    global_store_dwordx4 v14, v[10:13], s[14:15] offset:3072 sc1
    v_and_b32 v14, 63, v0
    v_lshlrev_b32 v14, 4, v14
    v_add_u32 v14, 32768, v14
    global_store_dwordx4 v14, v[10:13], s[14:15] offset:0 sc1
    global_store_dwordx4 v14, v[10:13], s[14:15] offset:1024 sc1
    s_waitcnt vmcnt(0)
    v_mov_b32 v10, 1
    v_mov_b32 v14, 0
    global_store_dword v14, v10, s[12:13] sc1
L_nozero:
    global_load_dwordx4 v[16:19], v1, s[16:17]
    s_add_u32 s16, s16, 12288
    s_addc_u32 s17, s17, 0
    global_load_dwordx4 v[20:23], v1, s[16:17]
    s_add_u32 s16, s16, 12288
    s_addc_u32 s17, s17, 0
    global_load_dwordx4 v[24:27], v1, s[16:17]
    s_add_u32 s16, s16, 12288
    s_addc_u32 s17, s17, 0
    global_load_dwordx4 v[28:31], v1, s[16:17]
    s_add_u32 s16, s16, 12288
    s_addc_u32 s17, s17, 0
    global_load_dwordx4 v[32:35], v1, s[16:17]
    s_add_u32 s16, s16, 12288
    s_addc_u32 s17, s17, 0
    global_load_dwordx4 v[36:39], v1, s[16:17]
    s_add_u32 s16, s16, 12288
    s_addc_u32 s17, s17, 0
    global_load_dwordx4 v[40:43], v1, s[16:17]
    s_add_u32 s16, s16, 12288
    s_addc_u32 s17, s17, 0
    global_load_dwordx4 v[44:47], v1, s[16:17]
    s_add_u32 s16, s16, 12288
    s_addc_u32 s17, s17, 0
    global_load_dwordx4 v[48:51], v1, s[16:17]
    s_add_u32 s16, s16, 12288
    s_addc_u32 s17, s17, 0
    global_load_dwordx4 v[52:55], v1, s[16:17]
    s_add_u32 s16, s16, 12288
    s_addc_u32 s17, s17, 0
    global_load_dwordx4 v[56:59], v1, s[16:17]
    s_add_u32 s16, s16, 12288
    s_addc_u32 s17, s17, 0
    global_load_dwordx4 v[60:63], v1, s[16:17]
    s_add_u32 s16, s16, 12288
    s_addc_u32 s17, s17, 0
    global_load_dwordx4 v[64:67], v1, s[16:17]
    s_add_u32 s16, s16, 12288
    s_addc_u32 s17, s17, 0
    global_load_dwordx4 v[68:71], v1, s[16:17]
    s_add_u32 s16, s16, 12288
    s_addc_u32 s17, s17, 0
    global_load_dwordx4 v[72:75], v1, s[16:17]
    s_add_u32 s16, s16, 12288
    s_addc_u32 s17, s17, 0
    global_load_dwordx4 v[76:79], v1, s[16:17]
    v_mul_u32_u24 v10, 2731, v0
    v_lshrrev_b32 v10, 16, v10
    v_mul_u32_u24 v11, 24, v10
    v_sub_u32 v11, v0, v11
    v_mul_u32_u24 v124, 576, v10
    v_lshl_add_u32 v124, v11, 1, v124
    v_mul_u32_u24 v127, 48, v10
    v_lshlrev_b32 v126, 2, v11
    global_load_ushort v80, v124, s[6:7] offset:0
    global_load_ushort v81, v124, s[6:7] offset:48
    global_load_ushort v82, v124, s[6:7] offset:96
    global_load_ushort v83, v124, s[6:7] offset:144
    global_load_ushort v84, v124, s[6:7] offset:192
    global_load_ushort v85, v124, s[6:7] offset:240
    global_load_ushort v86, v124, s[6:7] offset:288
    global_load_ushort v87, v124, s[6:7] offset:336
    global_load_ushort v88, v124, s[6:7] offset:384
    global_load_ushort v89, v124, s[6:7] offset:432
    global_load_ushort v90, v124, s[6:7] offset:480
    global_load_ushort v91, v124, s[6:7] offset:528
    v_subrev_u32 v125, 384, v0
    v_cmp_gt_u32 vcc, 384, v0
    s_nop 1
    v_cndmask_b32 v125, v125, v0, vcc
    v_lshlrev_b32 v125, 1, v125
    global_load_ushort v92, v125, s[8:9] offset:0
    global_load_ushort v93, v125, s[8:9] offset:768
    global_load_ushort v94, v125, s[8:9] offset:1536
    global_load_ushort v95, v125, s[8:9] offset:2304
    global_load_ushort v96, v125, s[8:9] offset:3072
    v_add_u32 v125, 3840, v125
    global_load_ushort v97, v125, s[8:9] offset:0
    global_load_ushort v98, v125, s[8:9] offset:768
    global_load_ushort v99, v125, s[8:9] offset:1536
    global_load_ushort v100, v125, s[8:9] offset:2304
    global_load_ushort v101, v125, s[8:9] offset:3072
    v_add_u32 v125, 3840, v125
    global_load_ushort v102, v125, s[8:9] offset:0
    global_load_ushort v103, v125, s[8:9] offset:768
    global_load_ushort v104, v125, s[8:9] offset:1536
    global_load_ushort v105, v125, s[8:9] offset:2304
    global_load_ushort v106, v125, s[8:9] offset:3072
    v_add_u32 v125, 3840, v125
    global_load_ushort v107, v125, s[8:9] offset:0
    global_load_ushort v108, v125, s[8:9] offset:768
    global_load_ushort v109, v125, s[8:9] offset:1536
    global_load_ushort v110, v125, s[8:9] offset:2304
    global_load_ushort v111, v125, s[8:9] offset:3072
    v_add_u32 v125, 3840, v125
    global_load_ushort v112, v125, s[8:9] offset:0
    global_load_ushort v113, v125, s[8:9] offset:768
    global_load_ushort v114, v125, s[8:9] offset:1536
    global_load_ushort v115, v125, s[8:9] offset:2304
    v_and_b32 v10, 31, v0
    v_lshlrev_b32 v10, 2, v10
    v_mov_b32 v11, 0
    ds_write_b32 v10, v11 offset:26112
    v_mov_b32 v2, 0
    v_mov_b32 v3, 0
    v_mov_b32 v4, 0
    v_mov_b32 v5, 0
    v_mov_b32 v6, 0
    v_mov_b32 v7, 0
    v_mov_b32 v8, 0
    v_mov_b32 v9, 0
    s_waitcnt vmcnt(51)
    v_lshlrev_b32 v10, 16, v16
    v_and_b32 v11, 0xffff0000, v16
    v_add_f32 v2, v2, v10
    v_add_f32 v3, v3, v11
    v_lshlrev_b32 v10, 16, v17
    v_and_b32 v11, 0xffff0000, v17
    v_add_f32 v4, v4, v10
    v_add_f32 v5, v5, v11
    v_lshlrev_b32 v10, 16, v18
    v_and_b32 v11, 0xffff0000, v18
    v_add_f32 v6, v6, v10
    v_add_f32 v7, v7, v11
    v_lshlrev_b32 v10, 16, v19
    v_and_b32 v11, 0xffff0000, v19
    v_add_f32 v8, v8, v10
    v_add_f32 v9, v9, v11
    s_waitcnt vmcnt(50)
    v_lshlrev_b32 v10, 16, v20
    v_and_b32 v11, 0xffff0000, v20
    v_add_f32 v2, v2, v10
    v_add_f32 v3, v3, v11
    v_lshlrev_b32 v10, 16, v21
    v_and_b32 v11, 0xffff0000, v21
    v_add_f32 v4, v4, v10
    v_add_f32 v5, v5, v11
    v_lshlrev_b32 v10, 16, v22
    v_and_b32 v11, 0xffff0000, v22
    v_add_f32 v6, v6, v10
    v_add_f32 v7, v7, v11
    v_lshlrev_b32 v10, 16, v23
    v_and_b32 v11, 0xffff0000, v23
    v_add_f32 v8, v8, v10
    v_add_f32 v9, v9, v11
    s_waitcnt vmcnt(49)
    v_lshlrev_b32 v10, 16, v24
    v_and_b32 v11, 0xffff0000, v24
    v_add_f32 v2, v2, v10
    v_add_f32 v3, v3, v11
    v_lshlrev_b32 v10, 16, v25
    v_and_b32 v11, 0xffff0000, v25
    v_add_f32 v4, v4, v10
    v_add_f32 v5, v5, v11
    v_lshlrev_b32 v10, 16, v26
    v_and_b32 v11, 0xffff0000, v26
    v_add_f32 v6, v6, v10
    v_add_f32 v7, v7, v11
    v_lshlrev_b32 v10, 16, v27
    v_and_b32 v11, 0xffff0000, v27
    v_add_f32 v8, v8, v10
    v_add_f32 v9, v9, v11
    s_waitcnt vmcnt(48)
    v_lshlrev_b32 v10, 16, v28
    v_and_b32 v11, 0xffff0000, v28
    v_add_f32 v2, v2, v10
    v_add_f32 v3, v3, v11
    v_lshlrev_b32 v10, 16, v29
    v_and_b32 v11, 0xffff0000, v29
    v_add_f32 v4, v4, v10
    v_add_f32 v5, v5, v11
    v_lshlrev_b32 v10, 16, v30
    v_and_b32 v11, 0xffff0000, v30
    v_add_f32 v6, v6, v10
    v_add_f32 v7, v7, v11
    v_lshlrev_b32 v10, 16, v31
    v_and_b32 v11, 0xffff0000, v31
    v_add_f32 v8, v8, v10
    v_add_f32 v9, v9, v11
    s_waitcnt vmcnt(47)
    v_lshlrev_b32 v10, 16, v32
    v_and_b32 v11, 0xffff0000, v32
    v_add_f32 v2, v2, v10
    v_add_f32 v3, v3, v11
    v_lshlrev_b32 v10, 16, v33
    v_and_b32 v11, 0xffff0000, v33
    v_add_f32 v4, v4, v10
    v_add_f32 v5, v5, v11
    v_lshlrev_b32 v10, 16, v34
    v_and_b32 v11, 0xffff0000, v34
    v_add_f32 v6, v6, v10
    v_add_f32 v7, v7, v11
    v_lshlrev_b32 v10, 16, v35
    v_and_b32 v11, 0xffff0000, v35
    v_add_f32 v8, v8, v10
    v_add_f32 v9, v9, v11
    s_waitcnt vmcnt(46)
    v_lshlrev_b32 v10, 16, v36
    v_and_b32 v11, 0xffff0000, v36
    v_add_f32 v2, v2, v10
    v_add_f32 v3, v3, v11
    v_lshlrev_b32 v10, 16, v37
    v_and_b32 v11, 0xffff0000, v37
    v_add_f32 v4, v4, v10
    v_add_f32 v5, v5, v11
    v_lshlrev_b32 v10, 16, v38
    v_and_b32 v11, 0xffff0000, v38
    v_add_f32 v6, v6, v10
    v_add_f32 v7, v7, v11
    v_lshlrev_b32 v10, 16, v39
    v_and_b32 v11, 0xffff0000, v39
    v_add_f32 v8, v8, v10
    v_add_f32 v9, v9, v11
    s_waitcnt vmcnt(45)
    v_lshlrev_b32 v10, 16, v40
    v_and_b32 v11, 0xffff0000, v40
    v_add_f32 v2, v2, v10
    v_add_f32 v3, v3, v11
    v_lshlrev_b32 v10, 16, v41
    v_and_b32 v11, 0xffff0000, v41
    v_add_f32 v4, v4, v10
    v_add_f32 v5, v5, v11
    v_lshlrev_b32 v10, 16, v42
    v_and_b32 v11, 0xffff0000, v42
    v_add_f32 v6, v6, v10
    v_add_f32 v7, v7, v11
    v_lshlrev_b32 v10, 16, v43
    v_and_b32 v11, 0xffff0000, v43
    v_add_f32 v8, v8, v10
    v_add_f32 v9, v9, v11
    s_waitcnt vmcnt(44)
    v_lshlrev_b32 v10, 16, v44
    v_and_b32 v11, 0xffff0000, v44
    v_add_f32 v2, v2, v10
    v_add_f32 v3, v3, v11
    v_lshlrev_b32 v10, 16, v45
    v_and_b32 v11, 0xffff0000, v45
    v_add_f32 v4, v4, v10
    v_add_f32 v5, v5, v11
    v_lshlrev_b32 v10, 16, v46
    v_and_b32 v11, 0xffff0000, v46
    v_add_f32 v6, v6, v10
    v_add_f32 v7, v7, v11
    v_lshlrev_b32 v10, 16, v47
    v_and_b32 v11, 0xffff0000, v47
    v_add_f32 v8, v8, v10
    v_add_f32 v9, v9, v11
    s_waitcnt vmcnt(43)
    v_lshlrev_b32 v10, 16, v48
    v_and_b32 v11, 0xffff0000, v48
    v_add_f32 v2, v2, v10
    v_add_f32 v3, v3, v11
    v_lshlrev_b32 v10, 16, v49
    v_and_b32 v11, 0xffff0000, v49
    v_add_f32 v4, v4, v10
    v_add_f32 v5, v5, v11
    v_lshlrev_b32 v10, 16, v50
    v_and_b32 v11, 0xffff0000, v50
    v_add_f32 v6, v6, v10
    v_add_f32 v7, v7, v11
    v_lshlrev_b32 v10, 16, v51
    v_and_b32 v11, 0xffff0000, v51
    v_add_f32 v8, v8, v10
    v_add_f32 v9, v9, v11
    s_waitcnt vmcnt(42)
    v_lshlrev_b32 v10, 16, v52
    v_and_b32 v11, 0xffff0000, v52
    v_add_f32 v2, v2, v10
    v_add_f32 v3, v3, v11
    v_lshlrev_b32 v10, 16, v53
    v_and_b32 v11, 0xffff0000, v53
    v_add_f32 v4, v4, v10
    v_add_f32 v5, v5, v11
    v_lshlrev_b32 v10, 16, v54
    v_and_b32 v11, 0xffff0000, v54
    v_add_f32 v6, v6, v10
    v_add_f32 v7, v7, v11
    v_lshlrev_b32 v10, 16, v55
    v_and_b32 v11, 0xffff0000, v55
    v_add_f32 v8, v8, v10
    v_add_f32 v9, v9, v11
    s_waitcnt vmcnt(41)
    v_lshlrev_b32 v10, 16, v56
    v_and_b32 v11, 0xffff0000, v56
    v_add_f32 v2, v2, v10
    v_add_f32 v3, v3, v11
    v_lshlrev_b32 v10, 16, v57
    v_and_b32 v11, 0xffff0000, v57
    v_add_f32 v4, v4, v10
    v_add_f32 v5, v5, v11
    v_lshlrev_b32 v10, 16, v58
    v_and_b32 v11, 0xffff0000, v58
    v_add_f32 v6, v6, v10
    v_add_f32 v7, v7, v11
    v_lshlrev_b32 v10, 16, v59
    v_and_b32 v11, 0xffff0000, v59
    v_add_f32 v8, v8, v10
    v_add_f32 v9, v9, v11
    s_waitcnt vmcnt(40)
    v_lshlrev_b32 v10, 16, v60
    v_and_b32 v11, 0xffff0000, v60
    v_add_f32 v2, v2, v10
    v_add_f32 v3, v3, v11
    v_lshlrev_b32 v10, 16, v61
    v_and_b32 v11, 0xffff0000, v61
    v_add_f32 v4, v4, v10
    v_add_f32 v5, v5, v11
    v_lshlrev_b32 v10, 16, v62
    v_and_b32 v11, 0xffff0000, v62
    v_add_f32 v6, v6, v10
    v_add_f32 v7, v7, v11
    v_lshlrev_b32 v10, 16, v63
    v_and_b32 v11, 0xffff0000, v63
    v_add_f32 v8, v8, v10
    v_add_f32 v9, v9, v11
    s_waitcnt vmcnt(39)
    v_lshlrev_b32 v10, 16, v64
    v_and_b32 v11, 0xffff0000, v64
    v_add_f32 v2, v2, v10
    v_add_f32 v3, v3, v11
    v_lshlrev_b32 v10, 16, v65
    v_and_b32 v11, 0xffff0000, v65
    v_add_f32 v4, v4, v10
    v_add_f32 v5, v5, v11
    v_lshlrev_b32 v10, 16, v66
    v_and_b32 v11, 0xffff0000, v66
    v_add_f32 v6, v6, v10
    v_add_f32 v7, v7, v11
    v_lshlrev_b32 v10, 16, v67
    v_and_b32 v11, 0xffff0000, v67
    v_add_f32 v8, v8, v10
    v_add_f32 v9, v9, v11
    s_waitcnt vmcnt(38)
    v_lshlrev_b32 v10, 16, v68
    v_and_b32 v11, 0xffff0000, v68
    v_add_f32 v2, v2, v10
    v_add_f32 v3, v3, v11
    v_lshlrev_b32 v10, 16, v69
    v_and_b32 v11, 0xffff0000, v69
    v_add_f32 v4, v4, v10
    v_add_f32 v5, v5, v11
    v_lshlrev_b32 v10, 16, v70
    v_and_b32 v11, 0xffff0000, v70
    v_add_f32 v6, v6, v10
    v_add_f32 v7, v7, v11
    v_lshlrev_b32 v10, 16, v71
    v_and_b32 v11, 0xffff0000, v71
    v_add_f32 v8, v8, v10
    v_add_f32 v9, v9, v11
    s_waitcnt vmcnt(37)
    v_lshlrev_b32 v10, 16, v72
    v_and_b32 v11, 0xffff0000, v72
    v_add_f32 v2, v2, v10
    v_add_f32 v3, v3, v11
    v_lshlrev_b32 v10, 16, v73
    v_and_b32 v11, 0xffff0000, v73
    v_add_f32 v4, v4, v10
    v_add_f32 v5, v5, v11
    v_lshlrev_b32 v10, 16, v74
    v_and_b32 v11, 0xffff0000, v74
    v_add_f32 v6, v6, v10
    v_add_f32 v7, v7, v11
    v_lshlrev_b32 v10, 16, v75
    v_and_b32 v11, 0xffff0000, v75
    v_add_f32 v8, v8, v10
    v_add_f32 v9, v9, v11
    s_waitcnt vmcnt(36)
    v_lshlrev_b32 v10, 16, v76
    v_and_b32 v11, 0xffff0000, v76
    v_add_f32 v2, v2, v10
    v_add_f32 v3, v3, v11
    v_lshlrev_b32 v10, 16, v77
    v_and_b32 v11, 0xffff0000, v77
    v_add_f32 v4, v4, v10
    v_add_f32 v5, v5, v11
    v_lshlrev_b32 v10, 16, v78
    v_and_b32 v11, 0xffff0000, v78
    v_add_f32 v6, v6, v10
    v_add_f32 v7, v7, v11
    v_lshlrev_b32 v10, 16, v79
    v_and_b32 v11, 0xffff0000, v79
    v_add_f32 v8, v8, v10
    v_add_f32 v9, v9, v11
    v_lshlrev_b32 v10, 5, v0
    ds_write_b128 v10, v[2:5] offset:0
    ds_write_b128 v10, v[6:9] offset:16
    s_cmp_lg_u32 s20, 0
    s_cbranch_scc1 L_flag_ok
    v_mov_b32 v14, 0
L_flag:
    global_load_dword v10, v14, s[12:13] sc1
    s_waitcnt vmcnt(0)
    v_readfirstlane_b32 s22, v10
    s_cmp_lg_u32 s22, 0
    s_cbranch_scc1 L_flag_ok
    s_sleep 1
    s_add_u32 s21, s21, 1
    s_cmp_lt_u32 s21, 200000
    s_cbranch_scc1 L_flag
L_flag_ok:
    s_waitcnt lgkmcnt(0)
    s_barrier
    s_cmp_ge_u32 s20, 6
    s_cbranch_scc1 L_skip_atomic
    v_lshlrev_b32 v14, 2, v0
    ds_read_b32 v116, v14 offset:0
    ds_read_b32 v117, v14 offset:1536
    ds_read_b32 v118, v14 offset:3072
    ds_read_b32 v119, v14 offset:4608
    ds_read_b32 v120, v14 offset:6144
    ds_read_b32 v121, v14 offset:7680
    ds_read_b32 v122, v14 offset:9216
    ds_read_b32 v123, v14 offset:10752
    ds_read_b32 v10, v14 offset:12288
    ds_read_b32 v11, v14 offset:13824
    ds_read_b32 v12, v14 offset:15360
    ds_read_b32 v13, v14 offset:16896
    ds_read_b32 v2, v14 offset:18432
    ds_read_b32 v3, v14 offset:19968
    ds_read_b32 v4, v14 offset:21504
    ds_read_b32 v5, v14 offset:23040
    s_waitcnt lgkmcnt(0)
    v_add_f32 v116, v116, v117
    v_add_f32 v118, v118, v119
    v_add_f32 v120, v120, v121
    v_add_f32 v122, v122, v123
    v_add_f32 v10, v10, v11
    v_add_f32 v12, v12, v13
    v_add_f32 v2, v2, v3
    v_add_f32 v4, v4, v5
    v_add_f32 v116, v116, v118
    v_add_f32 v120, v120, v122
    v_add_f32 v10, v10, v12
    v_add_f32 v2, v2, v4
    v_add_f32 v116, v116, v120
    v_add_f32 v10, v10, v2
    v_add_f32 v116, v116, v10
    global_atomic_add_f32 v14, v116, s[24:25]
    s_waitcnt vmcnt(0)
L_skip_atomic:
    s_barrier
    s_cmp_lg_u32 s20, 0
    s_cbranch_scc1 L_arrived
    s_and_b32 s22, s2, 15
    s_lshl_b32 s22, s22, 7
    s_add_u32 s22, s22, 32768
    v_mov_b32 v14, s22
    v_mov_b32 v10, 1
    s_mov_b64 s[28:29], exec
    s_mov_b64 exec, 1
    global_atomic_add v14, v10, s[14:15]
    s_mov_b64 exec, s[28:29]
    v_and_b32 v14, 15, v0
    v_lshlrev_b32 v14, 7, v14
    v_add_u32 v14, 32768, v14
L_poll:
    global_load_dword v10, v14, s[14:15] sc1
    s_waitcnt vmcnt(0)
    v_cmp_ne_u32 vcc, 16, v10
    s_nop 3
    s_cmp_eq_u64 vcc, 0
    s_cbranch_scc1 L_arrived
    s_add_u32 s21, s21, 1
    s_cmp_lt_u32 s21, 200000
    s_cbranch_scc1 L_poll
L_arrived:
    s_barrier
    s_cmp_ge_u32 s20, 6
    s_cbranch_scc1 L_skip_mean
    v_lshlrev_b32 v14, 2, v0
    global_load_dword v116, v14, s[14:15] offset:0 sc1
    global_load_dword v117, v14, s[14:15] offset:1536 sc1
    v_add_u32 v14, 3072, v14
    global_load_dword v118, v14, s[14:15] offset:0 sc1
    global_load_dword v119, v14, s[14:15] offset:1536 sc1
    v_add_u32 v14, 3072, v14
    global_load_dword v120, v14, s[14:15] offset:0 sc1
    global_load_dword v121, v14, s[14:15] offset:1536 sc1
    v_add_u32 v14, 3072, v14
    global_load_dword v122, v14, s[14:15] offset:0 sc1
    global_load_dword v123, v14, s[14:15] offset:1536 sc1
    s_waitcnt vmcnt(0)
    v_add_f32 v116, v116, v117
    v_add_f32 v118, v118, v119
    v_add_f32 v120, v120, v121
    v_add_f32 v122, v122, v123
    v_add_f32 v116, v116, v118
    v_add_f32 v120, v120, v122
    v_add_f32 v116, v116, v120
    v_mul_f32 v10, 0x37800000, v116
    v_cvt_pk_bf16_f32 v10, v10, v10
    v_lshlrev_b32 v10, 16, v10
    v_lshlrev_b32 v14, 2, v0
    ds_write_b32 v14, v10 offset:24576
    s_waitcnt lgkmcnt(0)
L_skip_mean:
    s_barrier
    ds_read_b128 v[116:119], v127 offset:24576
    ds_read_b128 v[120:123], v127 offset:24592
    ds_read_b128 v[10:13], v127 offset:24608
    v_lshlrev_b32 v80, 16, v80
    v_lshlrev_b32 v81, 16, v81
    v_lshlrev_b32 v82, 16, v82
    v_lshlrev_b32 v83, 16, v83
    v_lshlrev_b32 v84, 16, v84
    v_lshlrev_b32 v85, 16, v85
    v_lshlrev_b32 v86, 16, v86
    v_lshlrev_b32 v87, 16, v87
    v_lshlrev_b32 v88, 16, v88
    v_lshlrev_b32 v89, 16, v89
    v_lshlrev_b32 v90, 16, v90
    v_lshlrev_b32 v91, 16, v91
    v_lshlrev_b32 v92, 16, v92
    v_lshlrev_b32 v93, 16, v93
    v_lshlrev_b32 v94, 16, v94
    v_lshlrev_b32 v95, 16, v95
    v_lshlrev_b32 v96, 16, v96
    v_lshlrev_b32 v97, 16, v97
    v_lshlrev_b32 v98, 16, v98
    v_lshlrev_b32 v99, 16, v99
    v_lshlrev_b32 v100, 16, v100
    v_lshlrev_b32 v101, 16, v101
    v_lshlrev_b32 v102, 16, v102
    v_lshlrev_b32 v103, 16, v103
    v_lshlrev_b32 v104, 16, v104
    v_lshlrev_b32 v105, 16, v105
    v_lshlrev_b32 v106, 16, v106
    v_lshlrev_b32 v107, 16, v107
    v_lshlrev_b32 v108, 16, v108
    v_lshlrev_b32 v109, 16, v109
    v_lshlrev_b32 v110, 16, v110
    v_lshlrev_b32 v111, 16, v111
    v_lshlrev_b32 v112, 16, v112
    v_lshlrev_b32 v113, 16, v113
    v_lshlrev_b32 v114, 16, v114
    v_lshlrev_b32 v115, 16, v115
    s_waitcnt lgkmcnt(0)
    v_mul_f32 v14, v116, v80
    v_fmac_f32 v14, v117, v81
    v_fmac_f32 v14, v118, v82
    v_fmac_f32 v14, v119, v83
    v_fmac_f32 v14, v120, v84
    v_fmac_f32 v14, v121, v85
    v_fmac_f32 v14, v122, v86
    v_fmac_f32 v14, v123, v87
    v_fmac_f32 v14, v10, v88
    v_fmac_f32 v14, v11, v89
    v_fmac_f32 v14, v12, v90
    v_fmac_f32 v14, v13, v91
    ds_add_f32 v126, v14 offset:26112
    s_waitcnt lgkmcnt(0)
    s_barrier
    v_and_b32 v10, 31, v0
    v_lshlrev_b32 v10, 2, v10
    ds_read_b32 v10, v10 offset:26112
    s_waitcnt lgkmcnt(0)
    v_cvt_pk_bf16_f32 v10, v10, v10
    v_lshlrev_b32 v10, 16, v10
    v_mul_f32 v11, 0xbfb8aa3b, v10
    v_exp_f32 v11, v11
    s_nop 0
    v_add_f32 v11, 1.0, v11
    v_rcp_f32 v11, v11
    s_nop 0
    v_mul_f32 v10, v10, v11
    v_cvt_pk_bf16_f32 v10, v10, v10
    v_lshlrev_b32 v10, 16, v10
    s_nop 0
    v_readlane_b32 s40, v10, 0
    v_readlane_b32 s41, v10, 1
    v_readlane_b32 s42, v10, 2
    v_readlane_b32 s43, v10, 3
    v_readlane_b32 s44, v10, 4
    v_readlane_b32 s45, v10, 5
    v_readlane_b32 s46, v10, 6
    v_readlane_b32 s47, v10, 7
    v_readlane_b32 s48, v10, 8
    v_readlane_b32 s49, v10, 9
    v_readlane_b32 s50, v10, 10
    v_readlane_b32 s51, v10, 11
    v_readlane_b32 s52, v10, 12
    v_readlane_b32 s53, v10, 13
    v_readlane_b32 s54, v10, 14
    v_readlane_b32 s55, v10, 15
    v_readlane_b32 s56, v10, 16
    v_readlane_b32 s57, v10, 17
    v_readlane_b32 s58, v10, 18
    v_readlane_b32 s59, v10, 19
    v_readlane_b32 s60, v10, 20
    v_readlane_b32 s61, v10, 21
    v_readlane_b32 s62, v10, 22
    v_readlane_b32 s63, v10, 23
    s_nop 1
    v_mul_f32 v14, s40, v92
    v_fmac_f32 v14, s41, v93
    v_fmac_f32 v14, s42, v94
    v_fmac_f32 v14, s43, v95
    v_fmac_f32 v14, s44, v96
    v_fmac_f32 v14, s45, v97
    v_fmac_f32 v14, s46, v98
    v_fmac_f32 v14, s47, v99
    v_fmac_f32 v14, s48, v100
    v_fmac_f32 v14, s49, v101
    v_fmac_f32 v14, s50, v102
    v_fmac_f32 v14, s51, v103
    v_fmac_f32 v14, s52, v104
    v_fmac_f32 v14, s53, v105
    v_fmac_f32 v14, s54, v106
    v_fmac_f32 v14, s55, v107
    v_fmac_f32 v14, s56, v108
    v_fmac_f32 v14, s57, v109
    v_fmac_f32 v14, s58, v110
    v_fmac_f32 v14, s59, v111
    v_fmac_f32 v14, s60, v112
    v_fmac_f32 v14, s61, v113
    v_fmac_f32 v14, s62, v114
    v_fmac_f32 v14, s63, v115
    v_cvt_pk_bf16_f32 v14, v14, v14
    v_lshlrev_b32 v14, 16, v14
    v_mul_f32 v11, 0xbfb8aa3b, v14
    v_exp_f32 v11, v11
    s_nop 0
    v_add_f32 v11, 1.0, v11
    v_rcp_f32 v11, v11
    s_nop 0
    v_cvt_pk_bf16_f32 v11, v11, v11
    v_lshlrev_b32 v11, 16, v11
    v_subrev_u32 v10, 384, v0
    v_cmp_gt_u32 vcc, 384, v0
    s_nop 1
    v_cndmask_b32 v10, v10, v0, vcc
    v_lshlrev_b32 v10, 2, v10
    ds_write_b32 v10, v11 offset:26240
    s_waitcnt lgkmcnt(0)
    s_barrier
    v_mul_u32_u24 v10, 1366, v0
    v_lshrrev_b32 v10, 16, v10
    v_mul_u32_u24 v10, 48, v10
    v_sub_u32 v10, v0, v10
    v_lshlrev_b32 v10, 5, v10
    ds_read_b128 v[116:119], v10 offset:26240
    ds_read_b128 v[120:123], v10 offset:26256
    s_waitcnt lgkmcnt(0)
    v_lshlrev_b32 v10, 16, v16
    v_and_b32 v11, 0xffff0000, v16
    v_mul_f32 v10, v10, v116
    v_mul_f32 v11, v11, v117
    v_cvt_pk_bf16_f32 v16, v10, v11
    v_lshlrev_b32 v10, 16, v17
    v_and_b32 v11, 0xffff0000, v17
    v_mul_f32 v10, v10, v118
    v_mul_f32 v11, v11, v119
    v_cvt_pk_bf16_f32 v17, v10, v11
    v_lshlrev_b32 v10, 16, v18
    v_and_b32 v11, 0xffff0000, v18
    v_mul_f32 v10, v10, v120
    v_mul_f32 v11, v11, v121
    v_cvt_pk_bf16_f32 v18, v10, v11
    v_lshlrev_b32 v10, 16, v19
    v_and_b32 v11, 0xffff0000, v19
    v_mul_f32 v10, v10, v122
    v_mul_f32 v11, v11, v123
    v_cvt_pk_bf16_f32 v19, v10, v11
    global_store_dwordx4 v1, v[16:19], s[18:19]
    s_add_u32 s18, s18, 12288
    s_addc_u32 s19, s19, 0
    v_lshlrev_b32 v10, 16, v20
    v_and_b32 v11, 0xffff0000, v20
    v_mul_f32 v10, v10, v116
    v_mul_f32 v11, v11, v117
    v_cvt_pk_bf16_f32 v20, v10, v11
    v_lshlrev_b32 v10, 16, v21
    v_and_b32 v11, 0xffff0000, v21
    v_mul_f32 v10, v10, v118
    v_mul_f32 v11, v11, v119
    v_cvt_pk_bf16_f32 v21, v10, v11
    v_lshlrev_b32 v10, 16, v22
    v_and_b32 v11, 0xffff0000, v22
    v_mul_f32 v10, v10, v120
    v_mul_f32 v11, v11, v121
    v_cvt_pk_bf16_f32 v22, v10, v11
    v_lshlrev_b32 v10, 16, v23
    v_and_b32 v11, 0xffff0000, v23
    v_mul_f32 v10, v10, v122
    v_mul_f32 v11, v11, v123
    v_cvt_pk_bf16_f32 v23, v10, v11
    global_store_dwordx4 v1, v[20:23], s[18:19]
    s_add_u32 s18, s18, 12288
    s_addc_u32 s19, s19, 0
    v_lshlrev_b32 v10, 16, v24
    v_and_b32 v11, 0xffff0000, v24
    v_mul_f32 v10, v10, v116
    v_mul_f32 v11, v11, v117
    v_cvt_pk_bf16_f32 v24, v10, v11
    v_lshlrev_b32 v10, 16, v25
    v_and_b32 v11, 0xffff0000, v25
    v_mul_f32 v10, v10, v118
    v_mul_f32 v11, v11, v119
    v_cvt_pk_bf16_f32 v25, v10, v11
    v_lshlrev_b32 v10, 16, v26
    v_and_b32 v11, 0xffff0000, v26
    v_mul_f32 v10, v10, v120
    v_mul_f32 v11, v11, v121
    v_cvt_pk_bf16_f32 v26, v10, v11
    v_lshlrev_b32 v10, 16, v27
    v_and_b32 v11, 0xffff0000, v27
    v_mul_f32 v10, v10, v122
    v_mul_f32 v11, v11, v123
    v_cvt_pk_bf16_f32 v27, v10, v11
    global_store_dwordx4 v1, v[24:27], s[18:19]
    s_add_u32 s18, s18, 12288
    s_addc_u32 s19, s19, 0
    v_lshlrev_b32 v10, 16, v28
    v_and_b32 v11, 0xffff0000, v28
    v_mul_f32 v10, v10, v116
    v_mul_f32 v11, v11, v117
    v_cvt_pk_bf16_f32 v28, v10, v11
    v_lshlrev_b32 v10, 16, v29
    v_and_b32 v11, 0xffff0000, v29
    v_mul_f32 v10, v10, v118
    v_mul_f32 v11, v11, v119
    v_cvt_pk_bf16_f32 v29, v10, v11
    v_lshlrev_b32 v10, 16, v30
    v_and_b32 v11, 0xffff0000, v30
    v_mul_f32 v10, v10, v120
    v_mul_f32 v11, v11, v121
    v_cvt_pk_bf16_f32 v30, v10, v11
    v_lshlrev_b32 v10, 16, v31
    v_and_b32 v11, 0xffff0000, v31
    v_mul_f32 v10, v10, v122
    v_mul_f32 v11, v11, v123
    v_cvt_pk_bf16_f32 v31, v10, v11
    global_store_dwordx4 v1, v[28:31], s[18:19]
    s_add_u32 s18, s18, 12288
    s_addc_u32 s19, s19, 0
    v_lshlrev_b32 v10, 16, v32
    v_and_b32 v11, 0xffff0000, v32
    v_mul_f32 v10, v10, v116
    v_mul_f32 v11, v11, v117
    v_cvt_pk_bf16_f32 v32, v10, v11
    v_lshlrev_b32 v10, 16, v33
    v_and_b32 v11, 0xffff0000, v33
    v_mul_f32 v10, v10, v118
    v_mul_f32 v11, v11, v119
    v_cvt_pk_bf16_f32 v33, v10, v11
    v_lshlrev_b32 v10, 16, v34
    v_and_b32 v11, 0xffff0000, v34
    v_mul_f32 v10, v10, v120
    v_mul_f32 v11, v11, v121
    v_cvt_pk_bf16_f32 v34, v10, v11
    v_lshlrev_b32 v10, 16, v35
    v_and_b32 v11, 0xffff0000, v35
    v_mul_f32 v10, v10, v122
    v_mul_f32 v11, v11, v123
    v_cvt_pk_bf16_f32 v35, v10, v11
    global_store_dwordx4 v1, v[32:35], s[18:19]
    s_add_u32 s18, s18, 12288
    s_addc_u32 s19, s19, 0
    v_lshlrev_b32 v10, 16, v36
    v_and_b32 v11, 0xffff0000, v36
    v_mul_f32 v10, v10, v116
    v_mul_f32 v11, v11, v117
    v_cvt_pk_bf16_f32 v36, v10, v11
    v_lshlrev_b32 v10, 16, v37
    v_and_b32 v11, 0xffff0000, v37
    v_mul_f32 v10, v10, v118
    v_mul_f32 v11, v11, v119
    v_cvt_pk_bf16_f32 v37, v10, v11
    v_lshlrev_b32 v10, 16, v38
    v_and_b32 v11, 0xffff0000, v38
    v_mul_f32 v10, v10, v120
    v_mul_f32 v11, v11, v121
    v_cvt_pk_bf16_f32 v38, v10, v11
    v_lshlrev_b32 v10, 16, v39
    v_and_b32 v11, 0xffff0000, v39
    v_mul_f32 v10, v10, v122
    v_mul_f32 v11, v11, v123
    v_cvt_pk_bf16_f32 v39, v10, v11
    global_store_dwordx4 v1, v[36:39], s[18:19]
    s_add_u32 s18, s18, 12288
    s_addc_u32 s19, s19, 0
    v_lshlrev_b32 v10, 16, v40
    v_and_b32 v11, 0xffff0000, v40
    v_mul_f32 v10, v10, v116
    v_mul_f32 v11, v11, v117
    v_cvt_pk_bf16_f32 v40, v10, v11
    v_lshlrev_b32 v10, 16, v41
    v_and_b32 v11, 0xffff0000, v41
    v_mul_f32 v10, v10, v118
    v_mul_f32 v11, v11, v119
    v_cvt_pk_bf16_f32 v41, v10, v11
    v_lshlrev_b32 v10, 16, v42
    v_and_b32 v11, 0xffff0000, v42
    v_mul_f32 v10, v10, v120
    v_mul_f32 v11, v11, v121
    v_cvt_pk_bf16_f32 v42, v10, v11
    v_lshlrev_b32 v10, 16, v43
    v_and_b32 v11, 0xffff0000, v43
    v_mul_f32 v10, v10, v122
    v_mul_f32 v11, v11, v123
    v_cvt_pk_bf16_f32 v43, v10, v11
    global_store_dwordx4 v1, v[40:43], s[18:19]
    s_add_u32 s18, s18, 12288
    s_addc_u32 s19, s19, 0
    v_lshlrev_b32 v10, 16, v44
    v_and_b32 v11, 0xffff0000, v44
    v_mul_f32 v10, v10, v116
    v_mul_f32 v11, v11, v117
    v_cvt_pk_bf16_f32 v44, v10, v11
    v_lshlrev_b32 v10, 16, v45
    v_and_b32 v11, 0xffff0000, v45
    v_mul_f32 v10, v10, v118
    v_mul_f32 v11, v11, v119
    v_cvt_pk_bf16_f32 v45, v10, v11
    v_lshlrev_b32 v10, 16, v46
    v_and_b32 v11, 0xffff0000, v46
    v_mul_f32 v10, v10, v120
    v_mul_f32 v11, v11, v121
    v_cvt_pk_bf16_f32 v46, v10, v11
    v_lshlrev_b32 v10, 16, v47
    v_and_b32 v11, 0xffff0000, v47
    v_mul_f32 v10, v10, v122
    v_mul_f32 v11, v11, v123
    v_cvt_pk_bf16_f32 v47, v10, v11
    global_store_dwordx4 v1, v[44:47], s[18:19]
    s_add_u32 s18, s18, 12288
    s_addc_u32 s19, s19, 0
    v_lshlrev_b32 v10, 16, v48
    v_and_b32 v11, 0xffff0000, v48
    v_mul_f32 v10, v10, v116
    v_mul_f32 v11, v11, v117
    v_cvt_pk_bf16_f32 v48, v10, v11
    v_lshlrev_b32 v10, 16, v49
    v_and_b32 v11, 0xffff0000, v49
    v_mul_f32 v10, v10, v118
    v_mul_f32 v11, v11, v119
    v_cvt_pk_bf16_f32 v49, v10, v11
    v_lshlrev_b32 v10, 16, v50
    v_and_b32 v11, 0xffff0000, v50
    v_mul_f32 v10, v10, v120
    v_mul_f32 v11, v11, v121
    v_cvt_pk_bf16_f32 v50, v10, v11
    v_lshlrev_b32 v10, 16, v51
    v_and_b32 v11, 0xffff0000, v51
    v_mul_f32 v10, v10, v122
    v_mul_f32 v11, v11, v123
    v_cvt_pk_bf16_f32 v51, v10, v11
    global_store_dwordx4 v1, v[48:51], s[18:19]
    s_add_u32 s18, s18, 12288
    s_addc_u32 s19, s19, 0
    v_lshlrev_b32 v10, 16, v52
    v_and_b32 v11, 0xffff0000, v52
    v_mul_f32 v10, v10, v116
    v_mul_f32 v11, v11, v117
    v_cvt_pk_bf16_f32 v52, v10, v11
    v_lshlrev_b32 v10, 16, v53
    v_and_b32 v11, 0xffff0000, v53
    v_mul_f32 v10, v10, v118
    v_mul_f32 v11, v11, v119
    v_cvt_pk_bf16_f32 v53, v10, v11
    v_lshlrev_b32 v10, 16, v54
    v_and_b32 v11, 0xffff0000, v54
    v_mul_f32 v10, v10, v120
    v_mul_f32 v11, v11, v121
    v_cvt_pk_bf16_f32 v54, v10, v11
    v_lshlrev_b32 v10, 16, v55
    v_and_b32 v11, 0xffff0000, v55
    v_mul_f32 v10, v10, v122
    v_mul_f32 v11, v11, v123
    v_cvt_pk_bf16_f32 v55, v10, v11
    global_store_dwordx4 v1, v[52:55], s[18:19]
    s_add_u32 s18, s18, 12288
    s_addc_u32 s19, s19, 0
    v_lshlrev_b32 v10, 16, v56
    v_and_b32 v11, 0xffff0000, v56
    v_mul_f32 v10, v10, v116
    v_mul_f32 v11, v11, v117
    v_cvt_pk_bf16_f32 v56, v10, v11
    v_lshlrev_b32 v10, 16, v57
    v_and_b32 v11, 0xffff0000, v57
    v_mul_f32 v10, v10, v118
    v_mul_f32 v11, v11, v119
    v_cvt_pk_bf16_f32 v57, v10, v11
    v_lshlrev_b32 v10, 16, v58
    v_and_b32 v11, 0xffff0000, v58
    v_mul_f32 v10, v10, v120
    v_mul_f32 v11, v11, v121
    v_cvt_pk_bf16_f32 v58, v10, v11
    v_lshlrev_b32 v10, 16, v59
    v_and_b32 v11, 0xffff0000, v59
    v_mul_f32 v10, v10, v122
    v_mul_f32 v11, v11, v123
    v_cvt_pk_bf16_f32 v59, v10, v11
    global_store_dwordx4 v1, v[56:59], s[18:19]
    s_add_u32 s18, s18, 12288
    s_addc_u32 s19, s19, 0
    v_lshlrev_b32 v10, 16, v60
    v_and_b32 v11, 0xffff0000, v60
    v_mul_f32 v10, v10, v116
    v_mul_f32 v11, v11, v117
    v_cvt_pk_bf16_f32 v60, v10, v11
    v_lshlrev_b32 v10, 16, v61
    v_and_b32 v11, 0xffff0000, v61
    v_mul_f32 v10, v10, v118
    v_mul_f32 v11, v11, v119
    v_cvt_pk_bf16_f32 v61, v10, v11
    v_lshlrev_b32 v10, 16, v62
    v_and_b32 v11, 0xffff0000, v62
    v_mul_f32 v10, v10, v120
    v_mul_f32 v11, v11, v121
    v_cvt_pk_bf16_f32 v62, v10, v11
    v_lshlrev_b32 v10, 16, v63
    v_and_b32 v11, 0xffff0000, v63
    v_mul_f32 v10, v10, v122
    v_mul_f32 v11, v11, v123
    v_cvt_pk_bf16_f32 v63, v10, v11
    global_store_dwordx4 v1, v[60:63], s[18:19]
    s_add_u32 s18, s18, 12288
    s_addc_u32 s19, s19, 0
    v_lshlrev_b32 v10, 16, v64
    v_and_b32 v11, 0xffff0000, v64
    v_mul_f32 v10, v10, v116
    v_mul_f32 v11, v11, v117
    v_cvt_pk_bf16_f32 v64, v10, v11
    v_lshlrev_b32 v10, 16, v65
    v_and_b32 v11, 0xffff0000, v65
    v_mul_f32 v10, v10, v118
    v_mul_f32 v11, v11, v119
    v_cvt_pk_bf16_f32 v65, v10, v11
    v_lshlrev_b32 v10, 16, v66
    v_and_b32 v11, 0xffff0000, v66
    v_mul_f32 v10, v10, v120
    v_mul_f32 v11, v11, v121
    v_cvt_pk_bf16_f32 v66, v10, v11
    v_lshlrev_b32 v10, 16, v67
    v_and_b32 v11, 0xffff0000, v67
    v_mul_f32 v10, v10, v122
    v_mul_f32 v11, v11, v123
    v_cvt_pk_bf16_f32 v67, v10, v11
    global_store_dwordx4 v1, v[64:67], s[18:19]
    s_add_u32 s18, s18, 12288
    s_addc_u32 s19, s19, 0
    v_lshlrev_b32 v10, 16, v68
    v_and_b32 v11, 0xffff0000, v68
    v_mul_f32 v10, v10, v116
    v_mul_f32 v11, v11, v117
    v_cvt_pk_bf16_f32 v68, v10, v11
    v_lshlrev_b32 v10, 16, v69
    v_and_b32 v11, 0xffff0000, v69
    v_mul_f32 v10, v10, v118
    v_mul_f32 v11, v11, v119
    v_cvt_pk_bf16_f32 v69, v10, v11
    v_lshlrev_b32 v10, 16, v70
    v_and_b32 v11, 0xffff0000, v70
    v_mul_f32 v10, v10, v120
    v_mul_f32 v11, v11, v121
    v_cvt_pk_bf16_f32 v70, v10, v11
    v_lshlrev_b32 v10, 16, v71
    v_and_b32 v11, 0xffff0000, v71
    v_mul_f32 v10, v10, v122
    v_mul_f32 v11, v11, v123
    v_cvt_pk_bf16_f32 v71, v10, v11
    global_store_dwordx4 v1, v[68:71], s[18:19]
    s_add_u32 s18, s18, 12288
    s_addc_u32 s19, s19, 0
    v_lshlrev_b32 v10, 16, v72
    v_and_b32 v11, 0xffff0000, v72
    v_mul_f32 v10, v10, v116
    v_mul_f32 v11, v11, v117
    v_cvt_pk_bf16_f32 v72, v10, v11
    v_lshlrev_b32 v10, 16, v73
    v_and_b32 v11, 0xffff0000, v73
    v_mul_f32 v10, v10, v118
    v_mul_f32 v11, v11, v119
    v_cvt_pk_bf16_f32 v73, v10, v11
    v_lshlrev_b32 v10, 16, v74
    v_and_b32 v11, 0xffff0000, v74
    v_mul_f32 v10, v10, v120
    v_mul_f32 v11, v11, v121
    v_cvt_pk_bf16_f32 v74, v10, v11
    v_lshlrev_b32 v10, 16, v75
    v_and_b32 v11, 0xffff0000, v75
    v_mul_f32 v10, v10, v122
    v_mul_f32 v11, v11, v123
    v_cvt_pk_bf16_f32 v75, v10, v11
    global_store_dwordx4 v1, v[72:75], s[18:19]
    s_add_u32 s18, s18, 12288
    s_addc_u32 s19, s19, 0
    v_lshlrev_b32 v10, 16, v76
    v_and_b32 v11, 0xffff0000, v76
    v_mul_f32 v10, v10, v116
    v_mul_f32 v11, v11, v117
    v_cvt_pk_bf16_f32 v76, v10, v11
    v_lshlrev_b32 v10, 16, v77
    v_and_b32 v11, 0xffff0000, v77
    v_mul_f32 v10, v10, v118
    v_mul_f32 v11, v11, v119
    v_cvt_pk_bf16_f32 v77, v10, v11
    v_lshlrev_b32 v10, 16, v78
    v_and_b32 v11, 0xffff0000, v78
    v_mul_f32 v10, v10, v120
    v_mul_f32 v11, v11, v121
    v_cvt_pk_bf16_f32 v78, v10, v11
    v_lshlrev_b32 v10, 16, v79
    v_and_b32 v11, 0xffff0000, v79
    v_mul_f32 v10, v10, v122
    v_mul_f32 v11, v11, v123
    v_cvt_pk_bf16_f32 v79, v10, v11
    global_store_dwordx4 v1, v[76:79], s[18:19]
L_end:
    s_endpgm
.section .rodata,"a"
.p2align 6
.amdhsa_kernel standalone__channel_attn_se__vision_kernel
  .amdhsa_next_free_vgpr 128
  .amdhsa_next_free_sgpr 96
  .amdhsa_accum_offset 128
  .amdhsa_group_segment_fixed_size 0
  .amdhsa_kernarg_size 48
  .amdhsa_user_sgpr_count 2
  .amdhsa_user_sgpr_kernarg_segment_ptr 1
  .amdhsa_system_sgpr_workgroup_id_x 1
  .amdhsa_float_denorm_mode_32 3
.end_amdhsa_kernel
```
